```python
import torch

def _softmax(x, axis=-1):
    return torch.softmax(x, dim=axis)
def _gelu(x):
    return torch.nn.functional.gelu(x, approximate="tanh")
def _silu(x):
    return torch.nn.functional.silu(x)
def _sigmoid(x):
    return torch.sigmoid(x)
def _layernorm(x, axis=-1, eps=1e-5):
    m = x.mean(dim=axis, keepdim=True)
    v = x.var(dim=axis, keepdim=True, unbiased=False)
    return (x - m) / torch.sqrt(v + eps)
def _scatter_add(tgt, idx, src, axis=0):
    return tgt.clone().index_add_(axis, idx, src)
def _segment_sum(src, seg, n):
    out = torch.zeros((n,) + src.shape[1:], dtype=src.dtype)
    return out.index_add_(0, seg, src)
def _pad(x, pw):
    flat = tuple(v for pair in reversed(pw) for v in pair)
    return torch.nn.functional.pad(x, flat)

kernel_name = 'sequential_preLN__compressed_kv_cla__glu_gated_glu__decode'

def setup_inputs():

    _w = (lambda a: (lambda t: t.to(torch.bfloat16) if t.is_floating_point() else t)(torch.as_tensor(a)))
    def _A_setup():
        B, H, Sq, Sk, D, M = 1, 32, 1, 4096, 192, 640
        Dc = 4 * D
        return {
            "x": _w((lambda *s: torch.randn(*s, dtype=torch.bfloat16) * 0.05)(B, Sq, M)),
            "c_kv": _w((lambda *s: torch.randn(*s, dtype=torch.bfloat16) * 0.4)(B, Sk, Dc)),
            "w_q": _w((lambda *s: torch.randn(*s, dtype=torch.bfloat16) * 3.2)(M, H, D) * (M ** -0.5)),
            "w_uk": _w((lambda *s: torch.randn(*s, dtype=torch.bfloat16) * 3.2)(Dc, H, D) * (Dc ** -0.5)),
            "w_uv": _w((lambda *s: torch.randn(*s, dtype=torch.bfloat16) * 0.4)(Dc, H, D) * (Dc ** -0.5)),
            "w_o": _w((lambda *s: torch.randn(*s, dtype=torch.bfloat16) * 0.4)(H, D, M) * ((H * D) ** -0.5)),
        }
    _A_in = _A_setup()

    def _B_setup():
        B, S, D, F = 1, 1, 640, 1536
        return {
            "x": _w((lambda *s: torch.randn(*s, dtype=torch.bfloat16) * 0.05)(B, S, D)),
            "w_gate": _w((lambda *s: torch.randn(*s, dtype=torch.bfloat16) * 0.05)(D, F)),
            "w_up": _w((lambda *s: torch.randn(*s, dtype=torch.bfloat16) * 0.05)(D, F)),
            "w_down": _w((lambda *s: torch.randn(*s, dtype=torch.bfloat16) * 0.05)(F, D)),
        }
    _B_in = _B_setup()

    return {
        "A_x": _A_in["x"],
        "A_c_kv": _A_in["c_kv"],
        "A_w_q": _A_in["w_q"],
        "A_w_uk": _A_in["w_uk"],
        "A_w_uv": _A_in["w_uv"],
        "A_w_o": _A_in["w_o"],
        "B_x": _B_in["x"],
        "B_w_gate": _B_in["w_gate"],
        "B_w_up": _B_in["w_up"],
        "B_w_down": _B_in["w_down"],
    }

def reference(A_x, A_c_kv, A_w_q, A_w_uk, A_w_uv, A_w_o, B_x, B_w_gate, B_w_up, B_w_down):
    def _A_ref(x, c_kv, w_q, w_uk, w_uv, w_o):
        B, Sq, M = x.shape[0], x.shape[1], x.shape[2]
        Sk = c_kv.shape[1]
        H, D = w_q.shape[1], w_q.shape[2]
        q = torch.einsum("bqm,mhd->bhqd", x, w_q)
        k = torch.einsum("bkc,chd->bhkd", c_kv, w_uk)
        v = torch.einsum("bkc,chd->bhkd", c_kv, w_uv)
        scores = torch.einsum("bhqd,bhkd->bhqk", q, k) * (D ** -0.5)
        off = Sk - Sq
        qi = torch.arange(Sq)[:, None]
        kj = torch.arange(Sk)[None, :]
        cmask = kj <= (qi + off)
        scores = torch.where(cmask[None, None], scores, -1e9)
        p = _softmax(scores, axis=-1)
        ctx = torch.einsum("bhqk,bhkd->bhqd", p, v)
        return torch.einsum("bhqd,hdm->bqm", ctx, w_o)

    def _B_ref(x, w_gate, w_up, w_down):
        g = torch.einsum("bsd,df->bsf", x, w_gate)
        u = torch.einsum("bsd,df->bsf", x, w_up)
        h = _sigmoid(g) * u
        return torch.einsum("bsf,fd->bsd", h, w_down)

    x = A_x
    h = x + _A_ref(_layernorm(x, axis=-1), A_c_kv, A_w_q, A_w_uk, A_w_uv, A_w_o)
    h2 = h + _B_ref(_layernorm(h, axis=-1), B_w_gate, B_w_up, B_w_down)
    return h2
```

```asm
; @launch grid=(256,1,1) block=(512,1,1) lds=162816
.amdgcn_target "amdgcn-amd-amdhsa--gfx950"
.text
.globl sequential_preLN__compressed_kv_cla__glu_gated_glu__decode_kernel
.p2align 8
.type sequential_preLN__compressed_kv_cla__glu_gated_glu__decode_kernel,@function
.set CODE_KB, 17
sequential_preLN__compressed_kv_cla__glu_gated_glu__decode_kernel:
L_START:
    s_cmp_ge_u32 s2, 256
    s_cbranch_scc1 L_END
    s_load_dwordx16 s[4:19], s[0:1], 0
    s_load_dwordx8 s[20:27], s[0:1], 64
    s_load_dwordx2 s[28:29], s[0:1], 96
    v_and_b32 v1, 63, v0
    v_lshrrev_b32 v8, 6, v0
    v_and_b32 v2, 15, v0
    v_readfirstlane_b32 s30, v8
    v_lshrrev_b32 v3, 4, v1
    s_and_b32 s31, s2, 7
    s_lshr_b32 s32, s2, 3
    s_mov_b32 s70, 2097152
    s_cmp_lg_u32 s30, 7
    s_cbranch_scc1 NOPF_1
    s_cmp_ge_u32 s32, CODE_KB
    s_cbranch_scc1 NOPF_1
    s_getpc_b64 s[56:57]
L_PC_2:
    s_lshl_b32 s58, s32, 10
    s_sub_u32 s58, s58, L_PC_2-L_START
    s_ashr_i32 s59, s58, 31
    s_add_u32 s56, s56, s58
    s_addc_u32 s57, s57, s59
    v_lshlrev_b32 v9, 4, v1
    global_load_dwordx4 v[244:247], v9, s[56:57]
NOPF_1:
    s_waitcnt lgkmcnt(0)
    s_add_u32 s60, s28, 3571712
    s_addc_u32 s61, s29, 0
    s_load_dword s98, s[60:61], 0
    s_mov_b32 s36, s28
    s_and_b32 s37, s29, 0xffff
    s_mov_b32 s38, 4194304
    s_mov_b32 s39, 0x20000
    s_mov_b32 s44, s4
    s_and_b32 s45, s5, 0xffff
    s_mov_b32 s46, 1280
    s_mov_b32 s47, 0x20000
    s_lshr_b32 s56, s32, 2
    s_lshl_b32 s57, s31, 2
    s_add_u32 s56, s56, s57
    s_and_b32 s57, s32, 3
    s_sub_u32 s58, s32, 16
    s_lshr_b32 s59, s58, 1
    s_lshl_b32 s60, s31, 3
    s_add_u32 s59, s59, s60
    s_cmp_lt_u32 s32, 16
    s_cselect_b32 s34, s56, s58
    s_cselect_b32 s35, s57, s59
    s_cmp_ge_u32 s30, 4
    s_cbranch_scc1 L_BW
    s_cmp_ge_u32 s32, 24
    s_cbranch_scc1 L_ANOS1
    s_setprio 2
    s_cmp_ge_u32 s32, 12
    s_cselect_b32 s94, 1, 0
    s_mul_i32 s56, s94, 12
    s_sub_u32 s95, s32, s56
    v_lshlrev_b32 v73, 2, v1
    buffer_load_dword v24, v73, s[44:47], 0 offen offset:0
    buffer_load_dword v25, v73, s[44:47], 0 offen offset:256
    buffer_load_dword v26, v73, s[44:47], 0 offen offset:512
    buffer_load_dword v27, v73, s[44:47], 0 offen offset:768
    buffer_load_dword v28, v73, s[44:47], 0 offen offset:1024
    s_mul_i32 s56, s94, 320
    s_mul_i32 s57, s30, 80
    s_add_u32 s96, s56, s57
    s_lshl_b32 s56, s96, 1
    buffer_load_dword v29, v73, s[44:47], s56 offen
    s_mov_b32 s48, s8
    s_and_b32 s49, s9, 0xffff
    s_mov_b32 s50, 7864320
    s_mov_b32 s51, 0x20000
    v_lshrrev_b32 v73, 3, v2
    v_lshl_add_u32 v73, v3, 1, v73
    v_mul_u32_u24 v72, 12288, v73
    v_and_b32 v73, 7, v2
    v_lshl_add_u32 v72, v73, 4, v72
    s_mul_i32 s56, s96, 12288
    s_mul_i32 s57, s31, 1536
    s_add_u32 s56, s56, s57
    s_lshl_b32 s57, s95, 7
    s_add_u32 s56, s56, s57
    buffer_load_dwordx4 v[32:35], v72, s[48:51], s56 offen nt
    s_add_u32 s56, s56, 98304
    buffer_load_dwordx4 v[36:39], v72, s[48:51], s56 offen nt
    s_add_u32 s56, s56, 98304
    buffer_load_dwordx4 v[40:43], v72, s[48:51], s56 offen nt
    s_add_u32 s56, s56, 98304
    buffer_load_dwordx4 v[44:47], v72, s[48:51], s56 offen nt
    s_add_u32 s56, s56, 98304
    buffer_load_dwordx4 v[48:51], v72, s[48:51], s56 offen nt
    s_add_u32 s56, s56, 98304
    buffer_load_dwordx4 v[52:55], v72, s[48:51], s56 offen nt
    s_add_u32 s56, s56, 98304
    buffer_load_dwordx4 v[56:59], v72, s[48:51], s56 offen nt
    s_add_u32 s56, s56, 98304
    buffer_load_dwordx4 v[60:63], v72, s[48:51], s56 offen nt
    s_add_u32 s56, s56, 98304
    buffer_load_dwordx4 v[64:67], v72, s[48:51], s56 offen nt
    s_add_u32 s56, s56, 98304
    buffer_load_dwordx4 v[68:71], v72, s[48:51], s56 offen nt
    v_lshrrev_b32 v10, 3, v2
    v_mul_u32_u24 v10, 0x0202, v10
    v_add_u32 v10, 0x0100, v10
    v_lshlrev_b32 v11, 16, v10
    v_or_b32 v10, 0x0c0c0000, v10
    v_or_b32 v11, 0x00000c0c, v11
    v_and_b32 v8, 1, v2
    v_cmp_eq_u32 vcc, 1, v8
    s_nop 1
    v_cndmask_b32 v10, v10, v11, vcc
    v_bfe_u32 v11, v2, 1, 2
    v_mov_b32 v8, 0x0c0c0c0c
    v_cmp_eq_u32 vcc, 0, v11
    s_nop 1
    v_cndmask_b32 v4, v8, v10, vcc
    v_cmp_eq_u32 vcc, 1, v11
    s_nop 1
    v_cndmask_b32 v5, v8, v10, vcc
    v_cmp_eq_u32 vcc, 2, v11
    s_nop 1
    v_cndmask_b32 v6, v8, v10, vcc
    v_cmp_eq_u32 vcc, 3, v11
    s_nop 1
    v_cndmask_b32 v7, v8, v10, vcc
    v_mov_b32 v76, 157956
    s_cmp_lg_u32 s30, 0
    s_cbranch_scc1 IW_3
    v_mov_b32 v77, 157956
    v_mov_b32 v78, 0
    ds_write_b32 v77, v78
    ds_write_b32 v77, v78 offset:4
    ds_write_b32 v77, v78 offset:8
    s_waitcnt lgkmcnt(0)
IW_3:
    s_barrier
    s_lshl_b32 s64, s30, 8
    s_add_u32 s64, s64, 102400
    v_and_b32 v73, 3, v1
    v_mul_u32_u24 v74, 48, v73
    v_lshrrev_b32 v73, 2, v1
    v_lshl_add_u32 v74, v73, 2, v74
    v_add_u32 v74, s64, v74
    v_mul_u32_u24 v75, 48, v3
    v_add_u32 v75, s64, v75
    v_lshrrev_b32 v73, 1, v3
    s_lshl_b32 s56, s30, 1
    v_add_u32 v73, s56, v73
    v_mul_u32_u24 v80, 256, v73
    v_and_b32 v73, 7, v2
    v_lshlrev_b32 v73, 5, v73
    v_add_u32 v80, v80, v73
    v_and_b32 v73, 1, v3
    v_lshlrev_b32 v73, 4, v73
    v_add_u32 v80, v80, v73
    v_add_u32 v80, 98304, v80
    s_waitcnt lgkmcnt(0)
    s_add_u32 s98, s98, 0x9e3779b9
    s_xor_b32 s99, s98, 0x5bd1e995
    s_waitcnt vmcnt(10)
    v_lshlrev_b32 v81, 16, v24
    v_and_b32 v82, 0xffff0000, v24
    v_lshlrev_b32 v83, 16, v25
    v_and_b32 v84, 0xffff0000, v25
    v_lshlrev_b32 v85, 16, v26
    v_and_b32 v86, 0xffff0000, v26
    v_lshlrev_b32 v87, 16, v27
    v_and_b32 v88, 0xffff0000, v27
    v_lshlrev_b32 v89, 16, v28
    v_and_b32 v90, 0xffff0000, v28
    v_add_f32 v24, v81, v82
    v_add_f32 v25, v83, v84
    v_add_f32 v26, v85, v86
    v_add_f32 v27, v87, v88
    v_add_f32 v28, v89, v90
    v_add_f32 v24, v24, v25
    v_add_f32 v26, v26, v27
    v_add_f32 v91, v24, v26
    v_add_f32 v91, v91, v28
    s_nop 1
    v_add_f32_dpp v91, v91, v91 row_ror:8 row_mask:0xf bank_mask:0xf
    s_nop 1
    v_add_f32_dpp v91, v91, v91 row_ror:4 row_mask:0xf bank_mask:0xf
    s_nop 1
    v_add_f32_dpp v91, v91, v91 row_ror:2 row_mask:0xf bank_mask:0xf
    s_nop 1
    v_add_f32_dpp v91, v91, v91 row_ror:1 row_mask:0xf bank_mask:0xf
    v_mov_b32 v92, v91
    s_nop 1
    v_permlane16_swap_b32 v92, v91
    v_add_f32 v91, v91, v92
    v_mov_b32 v92, v91
    s_nop 1
    v_permlane32_swap_b32 v92, v91
    v_add_f32 v91, v91, v92
    v_mul_f32 v93, 0.0015625, v91
    v_sub_f32 v81, v81, v93
    v_sub_f32 v82, v82, v93
    v_sub_f32 v83, v83, v93
    v_sub_f32 v84, v84, v93
    v_sub_f32 v85, v85, v93
    v_sub_f32 v86, v86, v93
    v_sub_f32 v87, v87, v93
    v_sub_f32 v88, v88, v93
    v_sub_f32 v89, v89, v93
    v_sub_f32 v90, v90, v93
    v_mul_f32 v91, v81, v81
    v_mul_f32 v92, v82, v82
    v_fmac_f32 v91, v83, v83
    v_fmac_f32 v92, v84, v84
    v_fmac_f32 v91, v85, v85
    v_fmac_f32 v92, v86, v86
    v_fmac_f32 v91, v87, v87
    v_fmac_f32 v92, v88, v88
    v_fmac_f32 v91, v89, v89
    v_fmac_f32 v92, v90, v90
    v_add_f32 v91, v91, v92
    s_nop 1
    v_add_f32_dpp v91, v91, v91 row_ror:8 row_mask:0xf bank_mask:0xf
    s_nop 1
    v_add_f32_dpp v91, v91, v91 row_ror:4 row_mask:0xf bank_mask:0xf
    s_nop 1
    v_add_f32_dpp v91, v91, v91 row_ror:2 row_mask:0xf bank_mask:0xf
    s_nop 1
    v_add_f32_dpp v91, v91, v91 row_ror:1 row_mask:0xf bank_mask:0xf
    v_mov_b32 v92, v91
    s_nop 1
    v_permlane16_swap_b32 v92, v91
    v_add_f32 v91, v91, v92
    v_mov_b32 v92, v91
    s_nop 1
    v_permlane32_swap_b32 v92, v91
    v_add_f32 v91, v91, v92
    v_mov_b32 v92, 1e-05
    v_fmac_f32 v92, 0.0015625, v91
    v_rsq_f32 v94, v92
    v_lshlrev_b32 v73, 16, v29
    v_and_b32 v29, 0xffff0000, v29
    v_sub_f32 v73, v73, v93
    v_sub_f32 v29, v29, v93
    v_mul_f32 v73, v73, v94
    v_mul_f32 v29, v29, v94
    v_cvt_pk_bf16_f32 v29, v73, v29
    s_mov_b32 exec_lo, 0xffffffff
    s_mov_b32 exec_hi, 0xff
    ds_write_b32 v74, v29
    s_mov_b64 exec, -1
    ds_read_b128 v[96:99], v75 offset:0
    ds_read_b128 v[100:103], v75 offset:16
    ds_read_b64 v[104:105], v75 offset:32
    s_waitcnt lgkmcnt(0)
    s_waitcnt vmcnt(0)
    v_perm_b32 v108, v96, v96, v4
    v_perm_b32 v109, v96, v96, v5
    v_perm_b32 v110, v96, v96, v6
    v_perm_b32 v111, v96, v96, v7
    v_perm_b32 v112, v97, v97, v4
    v_perm_b32 v113, v97, v97, v5
    v_perm_b32 v114, v97, v97, v6
    v_perm_b32 v115, v97, v97, v7
    v_mfma_f32_16x16x32_bf16 v[116:119], v[32:35], v[108:111], 0
    v_perm_b32 v108, v98, v98, v4
    v_perm_b32 v109, v98, v98, v5
    v_perm_b32 v110, v98, v98, v6
    v_perm_b32 v111, v98, v98, v7
    v_mfma_f32_16x16x32_bf16 v[120:123], v[36:39], v[112:115], 0
    v_perm_b32 v112, v99, v99, v4
    v_perm_b32 v113, v99, v99, v5
    v_perm_b32 v114, v99, v99, v6
    v_perm_b32 v115, v99, v99, v7
    v_mfma_f32_16x16x32_bf16 v[116:119], v[40:43], v[108:111], v[116:119]
    v_perm_b32 v108, v100, v100, v4
    v_perm_b32 v109, v100, v100, v5
    v_perm_b32 v110, v100, v100, v6
    v_perm_b32 v111, v100, v100, v7
    v_mfma_f32_16x16x32_bf16 v[120:123], v[44:47], v[112:115], v[120:123]
    v_perm_b32 v112, v101, v101, v4
    v_perm_b32 v113, v101, v101, v5
    v_perm_b32 v114, v101, v101, v6
    v_perm_b32 v115, v101, v101, v7
    v_mfma_f32_16x16x32_bf16 v[116:119], v[48:51], v[108:111], v[116:119]
    v_perm_b32 v108, v102, v102, v4
    v_perm_b32 v109, v102, v102, v5
    v_perm_b32 v110, v102, v102, v6
    v_perm_b32 v111, v102, v102, v7
    v_mfma_f32_16x16x32_bf16 v[120:123], v[52:55], v[112:115], v[120:123]
    v_perm_b32 v112, v103, v103, v4
    v_perm_b32 v113, v103, v103, v5
    v_perm_b32 v114, v103, v103, v6
    v_perm_b32 v115, v103, v103, v7
    v_mfma_f32_16x16x32_bf16 v[116:119], v[56:59], v[108:111], v[116:119]
    v_perm_b32 v108, v104, v104, v4
    v_perm_b32 v109, v104, v104, v5
    v_perm_b32 v110, v104, v104, v6
    v_perm_b32 v111, v104, v104, v7
    v_mfma_f32_16x16x32_bf16 v[120:123], v[60:63], v[112:115], v[120:123]
    v_perm_b32 v112, v105, v105, v4
    v_perm_b32 v113, v105, v105, v5
    v_perm_b32 v114, v105, v105, v6
    v_perm_b32 v115, v105, v105, v7
    v_mfma_f32_16x16x32_bf16 v[116:119], v[64:67], v[108:111], v[116:119]
    s_nop 0
    v_mfma_f32_16x16x32_bf16 v[120:123], v[68:71], v[112:115], v[120:123]
    s_nop 7
    v_add_f32 v116, v116, v120
    v_add_f32 v117, v117, v121
    v_add_f32 v118, v118, v122
    v_add_f32 v119, v119, v123
    s_mov_b32 exec_lo, 0xff00ff
    s_mov_b32 exec_hi, 0xff00ff00
    ds_write_b128 v80, v[116:119] offset:0
    s_mov_b64 exec, -1
    s_waitcnt lgkmcnt(0)
    v_mov_b32 v77, 1
    s_mov_b64 exec, 1
    ds_add_u32 v76, v77
    s_mov_b64 exec, -1
    s_cmp_lg_u32 s30, 0
    s_cbranch_scc1 IW_4
CNT_5:
    ds_read_b32 v77, v76
    s_waitcnt lgkmcnt(0)
    v_cmp_ne_u32 vcc, 4, v77
    s_cbranch_vccz CNTD_6
    s_cmp_eq_u32 s70, 0
    s_cbranch_scc1 CNTD_6
    s_sub_u32 s70, s70, 1
    s_branch CNT_5
CNTD_6:
    v_lshlrev_b32 v80, 2, v1
    v_add_u32 v80, 98304, v80
    ds_read_b32 v124, v80 offset:0
    ds_read_b32 v125, v80 offset:256
    ds_read_b32 v126, v80 offset:512
    ds_read_b32 v127, v80 offset:768
    ds_read_b32 v128, v80 offset:1024
    ds_read_b32 v129, v80 offset:1280
    ds_read_b32 v130, v80 offset:1536
    ds_read_b32 v131, v80 offset:1792
    s_waitcnt lgkmcnt(0)
    v_add_f32 v124, v124, v128
    v_add_f32 v125, v125, v129
    v_add_f32 v126, v126, v130
    v_add_f32 v127, v127, v131
    v_add_f32 v124, v124, v126
    v_add_f32 v125, v125, v127
    v_add_f32 v132, v124, v125
    v_mov_b32 v134, s98
    v_mov_b32 v135, s99
    v_mov_b32_dpp v133, v132 row_shl:8 row_mask:0xf bank_mask:0xf
    v_and_b32 v136, 7, v1
    v_lshlrev_b32 v136, 2, v136
    v_lshrrev_b32 v73, 4, v1
    v_add_u32 v136, v136, v73
    v_lshlrev_b32 v136, 4, v136
    s_lshl_b32 s56, s31, 1
    s_add_u32 s56, s56, s94
    s_mul_i32 s56, s56, 6144
    s_lshl_b32 s57, s95, 9
    s_add_u32 s56, s56, s57
    s_add_u32 s56, s56, 3604480
    s_mov_b32 exec_lo, 0xff00ff
    s_mov_b32 exec_hi, 0xff00ff
    buffer_store_dwordx4 v[132:135], v136, s[36:39], s56 offen sc1
    s_mov_b64 exec, -1
IW_4:
    s_setprio 0
    s_cmp_lt_u32 s32, 16
    s_cbranch_scc1 L_XJ
    s_branch L_YA
L_ANOS1:
    v_lshrrev_b32 v10, 3, v2
    v_mul_u32_u24 v10, 0x0202, v10
    v_add_u32 v10, 0x0100, v10
    v_lshlrev_b32 v11, 16, v10
    v_or_b32 v10, 0x0c0c0000, v10
    v_or_b32 v11, 0x00000c0c, v11
    v_and_b32 v8, 1, v2
    v_cmp_eq_u32 vcc, 1, v8
    s_nop 1
    v_cndmask_b32 v10, v10, v11, vcc
    v_bfe_u32 v11, v2, 1, 2
    v_mov_b32 v8, 0x0c0c0c0c
    v_cmp_eq_u32 vcc, 0, v11
    s_nop 1
    v_cndmask_b32 v4, v8, v10, vcc
    v_cmp_eq_u32 vcc, 1, v11
    s_nop 1
    v_cndmask_b32 v5, v8, v10, vcc
    v_cmp_eq_u32 vcc, 2, v11
    s_nop 1
    v_cndmask_b32 v6, v8, v10, vcc
    v_cmp_eq_u32 vcc, 3, v11
    s_nop 1
    v_cndmask_b32 v7, v8, v10, vcc
    s_cmp_lg_u32 s30, 0
    s_cbranch_scc1 IW_7
    v_mov_b32 v24, 157956
    v_mov_b32 v25, 0
    ds_write_b32 v24, v25
    ds_write_b32 v24, v25 offset:4
    ds_write_b32 v24, v25 offset:8
    s_waitcnt lgkmcnt(0)
IW_7:
    s_barrier
    s_waitcnt lgkmcnt(0)
    s_add_u32 s98, s98, 0x9e3779b9
    s_xor_b32 s99, s98, 0x5bd1e995
    s_branch L_YA
L_BW:
    s_cmp_ge_u32 s32, 16
    s_cbranch_scc1 L_YB
L_XB:
    s_barrier
    v_add_u32 v12, 0, v1
    v_mul_u32_u24 v13, 171, v12
    v_lshrrev_b32 v13, 12, v13
    v_mul_u32_u24 v14, 24, v13
    v_sub_u32 v17, v12, v14
    v_bfe_u32 v12, v13, 1, 1
    v_xor_b32 v17, v17, v12
    v_lshlrev_b32 v17, 4, v17
    v_mul_u32_u24 v14, 12288, v13
    v_add_u32 v12, 64, v1
    v_mul_u32_u24 v13, 171, v12
    v_lshrrev_b32 v13, 12, v13
    v_mul_u32_u24 v15, 24, v13
    v_sub_u32 v18, v12, v15
    v_bfe_u32 v12, v13, 1, 1
    v_xor_b32 v18, v18, v12
    v_lshlrev_b32 v18, 4, v18
    v_mul_u32_u24 v15, 12288, v13
    v_add_u32 v12, 128, v1
    v_mul_u32_u24 v13, 171, v12
    v_lshrrev_b32 v13, 12, v13
    v_mul_u32_u24 v16, 24, v13
    v_sub_u32 v19, v12, v16
    v_bfe_u32 v12, v13, 1, 1
    v_xor_b32 v19, v19, v12
    v_lshlrev_b32 v19, 4, v19
    v_mul_u32_u24 v16, 12288, v13
    s_mov_b32 s52, s10
    s_and_b32 s53, s11, 0xffff
    s_mov_b32 s54, 9437184
    s_mov_b32 s55, 0x20000
    s_sub_u32 s61, s30, 4
    s_mul_i32 s56, s35, 192
    s_mul_i32 s57, s61, 48
    s_add_u32 s56, s56, s57
    s_mul_i32 s56, s56, 12288
    s_mul_i32 s57, s34, 384
    s_add_u32 s56, s56, s57
    s_mul_i32 s58, s61, 18432
    s_mul_i32 s59, s61, 6
    s_add_u32 s60, s59, 0
    s_and_b32 s60, s60, 3
    s_lshl_b32 s60, s60, 5
    v_xor_b32 v20, s60, v17
    v_add_u32 v20, v20, v14
    s_add_u32 m0, s58, 0
    s_nop 0
    buffer_load_dwordx4 v20, s[52:55], s56 offen nt lds
    v_xor_b32 v20, s60, v18
    v_add_u32 v20, v20, v15
    s_add_u32 m0, s58, 1024
    s_nop 0
    buffer_load_dwordx4 v20, s[52:55], s56 offen nt lds
    v_xor_b32 v20, s60, v19
    v_add_u32 v20, v20, v16
    s_add_u32 m0, s58, 2048
    s_nop 0
    buffer_load_dwordx4 v20, s[52:55], s56 offen nt lds
    s_add_u32 s56, s56, 98304
    s_add_u32 s60, s59, 1
    s_and_b32 s60, s60, 3
    s_lshl_b32 s60, s60, 5
    v_xor_b32 v20, s60, v17
    v_add_u32 v20, v20, v14
    s_add_u32 m0, s58, 3072
    s_nop 0
    buffer_load_dwordx4 v20, s[52:55], s56 offen nt lds
    v_xor_b32 v20, s60, v18
    v_add_u32 v20, v20, v15
    s_add_u32 m0, s58, 4096
    s_nop 0
    buffer_load_dwordx4 v20, s[52:55], s56 offen nt lds
    v_xor_b32 v20, s60, v19
    v_add_u32 v20, v20, v16
    s_add_u32 m0, s58, 5120
    s_nop 0
    buffer_load_dwordx4 v20, s[52:55], s56 offen nt lds
    s_add_u32 s56, s56, 98304
    s_add_u32 s60, s59, 2
    s_and_b32 s60, s60, 3
    s_lshl_b32 s60, s60, 5
    v_xor_b32 v20, s60, v17
    v_add_u32 v20, v20, v14
    s_add_u32 m0, s58, 6144
    s_nop 0
    buffer_load_dwordx4 v20, s[52:55], s56 offen nt lds
    v_xor_b32 v20, s60, v18
    v_add_u32 v20, v20, v15
    s_add_u32 m0, s58, 7168
    s_nop 0
    buffer_load_dwordx4 v20, s[52:55], s56 offen nt lds
    v_xor_b32 v20, s60, v19
    v_add_u32 v20, v20, v16
    s_add_u32 m0, s58, 8192
    s_nop 0
    buffer_load_dwordx4 v20, s[52:55], s56 offen nt lds
    s_add_u32 s56, s56, 98304
    s_add_u32 s60, s59, 3
    s_and_b32 s60, s60, 3
    s_lshl_b32 s60, s60, 5
    v_xor_b32 v20, s60, v17
    v_add_u32 v20, v20, v14
    s_add_u32 m0, s58, 9216
    s_nop 0
    buffer_load_dwordx4 v20, s[52:55], s56 offen nt lds
    v_xor_b32 v20, s60, v18
    v_add_u32 v20, v20, v15
    s_add_u32 m0, s58, 10240
    s_nop 0
    buffer_load_dwordx4 v20, s[52:55], s56 offen nt lds
    v_xor_b32 v20, s60, v19
    v_add_u32 v20, v20, v16
    s_add_u32 m0, s58, 11264
    s_nop 0
    buffer_load_dwordx4 v20, s[52:55], s56 offen nt lds
    s_add_u32 s56, s56, 98304
    s_add_u32 s60, s59, 4
    s_and_b32 s60, s60, 3
    s_lshl_b32 s60, s60, 5
    v_xor_b32 v20, s60, v17
    v_add_u32 v20, v20, v14
    s_add_u32 m0, s58, 12288
    s_nop 0
    buffer_load_dwordx4 v20, s[52:55], s56 offen nt lds
    v_xor_b32 v20, s60, v18
    v_add_u32 v20, v20, v15
    s_add_u32 m0, s58, 13312
    s_nop 0
    buffer_load_dwordx4 v20, s[52:55], s56 offen nt lds
    v_xor_b32 v20, s60, v19
    v_add_u32 v20, v20, v16
    s_add_u32 m0, s58, 14336
    s_nop 0
    buffer_load_dwordx4 v20, s[52:55], s56 offen nt lds
    s_add_u32 s56, s56, 98304
    s_waitcnt lgkmcnt(0)
    s_add_u32 s98, s98, 0x9e3779b9
    s_xor_b32 s99, s98, 0x5bd1e995
    s_add_u32 s60, s59, 5
    s_and_b32 s60, s60, 3
    s_lshl_b32 s60, s60, 5
    v_xor_b32 v20, s60, v17
    v_add_u32 v20, v20, v14
    s_add_u32 m0, s58, 15360
    s_nop 0
    buffer_load_dwordx4 v20, s[52:55], s56 offen nt lds
    v_xor_b32 v20, s60, v18
    v_add_u32 v20, v20, v15
    s_add_u32 m0, s58, 16384
    s_nop 0
    buffer_load_dwordx4 v20, s[52:55], s56 offen nt lds
    v_xor_b32 v20, s60, v19
    v_add_u32 v20, v20, v16
    s_add_u32 m0, s58, 17408
    s_nop 0
    buffer_load_dwordx4 v20, s[52:55], s56 offen nt lds
    v_lshrrev_b32 v10, 3, v2
    v_mul_u32_u24 v10, 0x0202, v10
    v_add_u32 v10, 0x0100, v10
    v_lshlrev_b32 v11, 16, v10
    v_or_b32 v10, 0x0c0c0000, v10
    v_or_b32 v11, 0x00000c0c, v11
    v_and_b32 v8, 1, v2
    v_cmp_eq_u32 vcc, 1, v8
    s_nop 1
    v_cndmask_b32 v10, v10, v11, vcc
    v_bfe_u32 v11, v2, 1, 2
    v_mov_b32 v8, 0x0c0c0c0c
    v_cmp_eq_u32 vcc, 0, v11
    s_nop 1
    v_cndmask_b32 v4, v8, v10, vcc
    v_cmp_eq_u32 vcc, 1, v11
    s_nop 1
    v_cndmask_b32 v5, v8, v10, vcc
    v_cmp_eq_u32 vcc, 2, v11
    s_nop 1
    v_cndmask_b32 v6, v8, v10, vcc
    v_cmp_eq_u32 vcc, 3, v11
    s_nop 1
    v_cndmask_b32 v7, v8, v10, vcc
    s_cmp_lg_u32 s30, 7
    s_cbranch_scc1 IW_8
    s_getreg_b32 s62, hwreg(HW_REG_XCC_ID)
    s_and_b32 s62, s62, 15
    v_mov_b32 v28, s98
    v_mov_b32 v29, s62
    s_lshl_b32 s62, s2, 3
    s_add_u32 s62, s62, 3563520
    v_mov_b32 v30, 0
    s_mov_b64 exec, 1
    buffer_store_dwordx2 v[28:29], v30, s[36:39], s62 offen sc1
    s_mov_b64 exec, -1
IW_8:
L_XJ:
    v_lshrrev_b32 v12, 2, v2
    v_lshlrev_b32 v13, 3, v12
    v_and_b32 v14, 3, v2
    v_add_u32 v14, v14, v13
    s_lshl_b32 s56, s30, 5
    v_add_u32 v14, s56, v14
    v_mul_u32_u24 v14, 384, v14
    v_add_u32 v14, 0, v14
    v_lshlrev_b32 v12, 1, v12
    v_bfe_u32 v13, v2, 1, 1
    v_or_b32 v12, v12, v13
    v_xor_b32 v12, v12, v3
    v_lshlrev_b32 v12, 4, v12
    v_xor_b32 v13, 64, v12
    v_add_u32 v15, v14, v13
    v_add_u32 v14, v14, v12
    v_lshrrev_b32 v12, 3, v2
    v_mul_u32_u24 v16, 384, v12
    v_lshl_add_u32 v16, v3, 4, v16
    v_add_u32 v16, 90112, v16
    s_mul_i32 s56, s34, 1536
    s_mul_i32 s57, s35, 384
    s_add_u32 s56, s56, s57
    s_lshl_b32 s57, s30, 6
    s_add_u32 s96, s56, s57
    v_lshlrev_b32 v17, 4, v3
    s_cmp_lg_u32 s30, 0
    s_cbranch_scc1 IW_9
    v_lshlrev_b32 v44, 5, v1
    s_mul_i32 s56, s31, 12288
    s_lshr_b32 s57, s32, 2
    s_mul_i32 s57, s57, 1536
    s_add_u32 s94, s56, s57
    s_add_u32 s94, s94, 3604480
    s_add_u32 s95, s94, 6144
    v_lshlrev_b32 v45, 3, v1
    v_add_u32 v45, 90112, v45
    s_mov_b32 exec_lo, 0xffffffff
    s_mov_b32 exec_hi, 0xffff
H1P_10:
    buffer_load_dwordx4 v[20:23], v44, s[36:39], s94 offen offset:0 sc1
    buffer_load_dwordx4 v[24:27], v44, s[36:39], s94 offen offset:16 sc1
    buffer_load_dwordx4 v[28:31], v44, s[36:39], s95 offen offset:0 sc1
    buffer_load_dwordx4 v[32:35], v44, s[36:39], s95 offen offset:16 sc1
    s_waitcnt vmcnt(0)
    v_mov_b32 v12, 0
    v_xor_b32 v13, s98, v22
    v_xor_b32 v36, s99, v23
    v_or3_b32 v12, v12, v13, v36
    v_xor_b32 v13, s98, v26
    v_xor_b32 v36, s99, v27
    v_or3_b32 v12, v12, v13, v36
    v_xor_b32 v13, s98, v30
    v_xor_b32 v36, s99, v31
    v_or3_b32 v12, v12, v13, v36
    v_xor_b32 v13, s98, v34
    v_xor_b32 v36, s99, v35
    v_or3_b32 v12, v12, v13, v36
    v_cmp_ne_u32 vcc, 0, v12
    s_cbranch_vccz H1D_11
    s_cmp_eq_u32 s70, 0
    s_cbranch_scc1 H1D_11
    s_sub_u32 s70, s70, 1
    s_branch H1P_10
H1D_11:
    v_add_f32 v36, v20, v28
    v_add_f32 v37, v21, v29
    v_add_f32 v38, v24, v32
    v_add_f32 v39, v25, v33
    s_mov_b32 s56, 0.10411754627697264
    v_mul_f32 v36, s56, v36
    v_mul_f32 v37, s56, v37
    v_mul_f32 v38, s56, v38
    v_mul_f32 v39, s56, v39
    v_cvt_pk_bf16_f32 v40, v36, v37
    v_cvt_pk_bf16_f32 v41, v38, v39
    v_lshlrev_b32 v12, 16, v40
    v_sub_f32 v36, v36, v12
    v_and_b32 v12, 0xffff0000, v40
    v_sub_f32 v37, v37, v12
    v_lshlrev_b32 v12, 16, v41
    v_sub_f32 v38, v38, v12
    v_and_b32 v12, 0xffff0000, v41
    v_sub_f32 v39, v39, v12
    v_cvt_pk_bf16_f32 v42, v36, v37
    v_cvt_pk_bf16_f32 v43, v38, v39
    ds_write_b64 v45, v[40:41]
    ds_write_b64 v45, v[42:43] offset:384
    s_mov_b64 exec, -1
IW_9:
    s_cmp_lg_u32 s30, 1
    s_cbranch_scc1 IW_12
    v_lshlrev_b32 v20, 4, v1
    s_mov_b32 s58, 3538944
FLG_13:
    buffer_load_dwordx2 v[18:19], v20, s[36:39], s58 offen sc1
    s_waitcnt vmcnt(0)
    v_xor_b32 v18, s98, v18
    v_xor_b32 v19, s99, v19
    v_or_b32 v21, v18, v19
    v_cmp_ne_u32 vcc, 0, v21
    s_cbranch_vccz FLGD_14
    s_cmp_eq_u32 s70, 0
    s_cbranch_scc1 FLGD_14
    s_sub_u32 s70, s70, 1
    s_branch FLG_13
FLGD_14:
IW_12:
    s_waitcnt vmcnt(0) lgkmcnt(0)
    s_barrier
    s_cmp_ge_u32 s30, 6
    s_cbranch_scc1 IW_15
    ds_read_b128 v[20:23], v16 offset:0
    ds_read_b128 v[44:47], v14 offset:0
    ds_read_b128 v[48:51], v14 offset:1536
    ds_read_b128 v[24:27], v16 offset:64
    ds_read_b128 v[52:55], v15 offset:0
    ds_read_b128 v[56:59], v15 offset:1536
    ds_read_b128 v[28:31], v16 offset:128
    ds_read_b128 v[60:63], v14 offset:128
    ds_read_b128 v[64:67], v14 offset:1664
    ds_read_b128 v[32:35], v16 offset:192
    ds_read_b128 v[68:71], v15 offset:128
    ds_read_b128 v[72:75], v15 offset:1664
    ds_read_b128 v[36:39], v16 offset:256
    ds_read_b128 v[76:79], v14 offset:256
    ds_read_b128 v[80:83], v14 offset:1792
    ds_read_b128 v[40:43], v16 offset:320
    ds_read_b128 v[84:87], v15 offset:256
    ds_read_b128 v[88:91], v15 offset:1792
    s_waitcnt lgkmcnt(15)
    v_mfma_f32_16x16x32_bf16 v[92:95], v[44:47], v[20:23], 0
    v_mfma_f32_16x16x32_bf16 v[96:99], v[48:51], v[20:23], 0
    s_waitcnt lgkmcnt(12)
    v_mfma_f32_16x16x32_bf16 v[92:95], v[52:55], v[24:27], v[92:95]
    v_mfma_f32_16x16x32_bf16 v[96:99], v[56:59], v[24:27], v[96:99]
    s_waitcnt lgkmcnt(9)
    v_mfma_f32_16x16x32_bf16 v[92:95], v[60:63], v[28:31], v[92:95]
    v_mfma_f32_16x16x32_bf16 v[96:99], v[64:67], v[28:31], v[96:99]
    s_waitcnt lgkmcnt(6)
    v_mfma_f32_16x16x32_bf16 v[92:95], v[68:71], v[32:35], v[92:95]
    v_mfma_f32_16x16x32_bf16 v[96:99], v[72:75], v[32:35], v[96:99]
    s_waitcnt lgkmcnt(3)
    v_mfma_f32_16x16x32_bf16 v[92:95], v[76:79], v[36:39], v[92:95]
    v_mfma_f32_16x16x32_bf16 v[96:99], v[80:83], v[36:39], v[96:99]
    s_waitcnt lgkmcnt(0)
    v_mfma_f32_16x16x32_bf16 v[92:95], v[84:87], v[40:43], v[92:95]
    v_mfma_f32_16x16x32_bf16 v[96:99], v[88:91], v[40:43], v[96:99]
    s_nop 6
    v_add_f32_dpp v92, v92, v92 row_ror:8 row_mask:0xf bank_mask:0xf
    v_add_f32_dpp v93, v93, v93 row_ror:8 row_mask:0xf bank_mask:0xf
    v_add_f32_dpp v94, v94, v94 row_ror:8 row_mask:0xf bank_mask:0xf
    v_add_f32_dpp v95, v95, v95 row_ror:8 row_mask:0xf bank_mask:0xf
    v_add_f32_dpp v96, v96, v96 row_ror:8 row_mask:0xf bank_mask:0xf
    v_add_f32_dpp v97, v97, v97 row_ror:8 row_mask:0xf bank_mask:0xf
    v_add_f32_dpp v98, v98, v98 row_ror:8 row_mask:0xf bank_mask:0xf
    v_add_f32_dpp v99, v99, v99 row_ror:8 row_mask:0xf bank_mask:0xf
    v_cvt_pk_bf16_f32 v100, v92, v93
    v_cvt_pk_bf16_f32 v101, v94, v95
    v_cvt_pk_bf16_f32 v102, v96, v97
    v_cvt_pk_bf16_f32 v103, v98, v99
    v_min_u32 v100, 0xfffffffe, v100
    v_min_u32 v101, 0xfffffffe, v101
    v_min_u32 v102, 0xfffffffe, v102
    v_min_u32 v103, 0xfffffffe, v103
    s_mov_b32 exec_lo, 0x10001
    s_mov_b32 exec_hi, 0x10001
    buffer_store_dwordx4 v[100:103], v17, s[36:39], s96 offen sc1
    s_mov_b64 exec, -1
IW_15:
    s_cmp_ge_u32 s32, 12
    s_cbranch_scc1 L_ROLE_FFN
    s_mul_i32 s56, s32, 11
    s_lshr_b32 s56, s56, 5
    s_mov_b32 s97, s56
    s_mul_i32 s57, s56, 3
    s_sub_u32 s35, s32, s57
    s_lshl_b32 s34, s31, 2
    s_add_u32 s34, s34, s56
    s_mov_b32 s48, s12
    s_and_b32 s49, s13, 0xffff
    s_mov_b32 s50, 9437184
    s_mov_b32 s51, 0x20000
    v_lshrrev_b32 v12, 3, v2
    v_lshl_add_u32 v12, v3, 1, v12
    v_mul_u32_u24 v64, 12288, v12
    v_and_b32 v12, 7, v2
    v_lshl_add_u32 v64, v12, 4, v64
    s_lshl_b32 s56, s35, 8
    s_lshl_b32 s57, s30, 5
    s_add_u32 s56, s56, s57
    s_mul_i32 s56, s56, 12288
    s_mul_i32 s57, s34, 384
    s_add_u32 s56, s56, s57
    buffer_load_dwordx4 v[16:19], v64, s[48:51], s56 offen offset:0 nt
    buffer_load_dwordx4 v[20:23], v64, s[48:51], s56 offen offset:128 nt
    buffer_load_dwordx4 v[24:27], v64, s[48:51], s56 offen offset:256 nt
    s_add_u32 s56, s56, 98304
    s_waitcnt vmcnt(0)
    buffer_load_dwordx4 v[28:31], v64, s[48:51], s56 offen offset:0 nt
    buffer_load_dwordx4 v[32:35], v64, s[48:51], s56 offen offset:128 nt
    buffer_load_dwordx4 v[36:39], v64, s[48:51], s56 offen offset:256 nt
    s_add_u32 s56, s56, 98304
    s_waitcnt vmcnt(0)
    buffer_load_dwordx4 v[40:43], v64, s[48:51], s56 offen offset:0 nt
    buffer_load_dwordx4 v[44:47], v64, s[48:51], s56 offen offset:128 nt
    buffer_load_dwordx4 v[48:51], v64, s[48:51], s56 offen offset:256 nt
    s_add_u32 s56, s56, 98304
    s_waitcnt vmcnt(0)
    buffer_load_dwordx4 v[52:55], v64, s[48:51], s56 offen offset:0 nt
    buffer_load_dwordx4 v[56:59], v64, s[48:51], s56 offen offset:128 nt
    buffer_load_dwordx4 v[60:63], v64, s[48:51], s56 offen offset:256 nt
    v_lshlrev_b32 v84, 8, v1
    s_lshl_b32 s94, s34, 3
    s_add_u32 s94, s94, 49152
    v_lshrrev_b32 v12, 3, v2
    v_lshl_add_u32 v12, v3, 1, v12
    v_mul_u32_u24 v85, 1536, v12
    v_and_b32 v12, 7, v2
    v_lshl_add_u32 v85, v12, 4, v85
    s_mul_i32 s95, s34, 98304
    s_mul_i32 s56, s30, 12288
    s_add_u32 s95, s95, s56
    s_lshl_b32 s56, s35, 9
    s_add_u32 s95, s95, s56
    s_add_u32 s95, s95, 327680
    v_lshrrev_b32 v12, 3, v2
    v_lshl_add_u32 v12, v3, 1, v12
    v_lshlrev_b32 v90, 2, v12
    s_lshl_b32 s56, s30, 3
    v_add_u32 v86, s56, v12
    v_lshlrev_b32 v86, 2, v86
    v_lshrrev_b32 v12, 1, v3
    s_lshl_b32 s56, s30, 1
    v_add_u32 v12, s56, v12
    v_mul_u32_u24 v87, 1024, v12
    v_and_b32 v12, 7, v2
    v_lshlrev_b32 v12, 5, v12
    v_add_u32 v87, v87, v12
    v_and_b32 v12, 1, v3
    v_lshlrev_b32 v12, 4, v12
    v_add_u32 v87, v87, v12
    v_add_u32 v87, 73728, v87
    v_lshrrev_b32 v12, 1, v3
    s_lshl_b32 s56, s30, 1
    v_add_u32 v12, s56, v12
    v_mul_u32_u24 v88, 768, v12
    v_and_b32 v12, 7, v2
    v_lshlrev_b32 v12, 5, v12
    v_add_u32 v88, v88, v12
    v_and_b32 v12, 1, v3
    v_lshlrev_b32 v12, 4, v12
    v_add_u32 v88, v88, v12
    v_add_u32 v88, 110592, v88
    s_lshl_b32 s56, s30, 5
    v_add_u32 v13, s56, v1
    v_and_b32 v89, 7, v13
    v_lshlrev_b32 v89, 3, v89
    v_bfe_u32 v12, v13, 3, 3
    v_add_u32 v89, v89, v12
    v_and_b32 v12, 0xffffffc0, v13
    v_add_u32 v89, v89, v12
    v_lshlrev_b32 v89, 2, v89
    v_add_u32 v89, 73728, v89
    v_lshlrev_b32 v91, 2, v0
    v_add_u32 v91, 110592, v91
    v_and_b32 v92, 7, v0
    v_lshlrev_b32 v92, 3, v92
    v_bfe_u32 v12, v0, 3, 3
    v_add_u32 v92, v92, v12
    v_and_b32 v12, 0xffffffc0, v0
    v_add_u32 v92, v92, v12
    v_lshlrev_b32 v92, 2, v92
    s_mul_i32 s56, s31, 3
    s_add_u32 s56, s56, s35
    s_mul_i32 s56, s56, 3072
    s_mul_i32 s57, s97, 768
    s_add_u32 s56, s56, s57
    s_add_u32 s96, s56, 65536
    s_waitcnt vmcnt(0)
    s_cmp_ge_u32 s30, 3
    s_cbranch_scc1 IW_16
    v_lshlrev_b32 v96, 6, v1
    s_lshl_b32 s56, s31, 3
    s_add_u32 s56, s56, 3563520
    s_getreg_b32 s57, hwreg(HW_REG_XCC_ID)
    s_and_b32 s57, s57, 15
    s_mov_b32 exec_lo, 0xffffffff
    s_mov_b32 exec_hi, 0x0
XC_17:
    buffer_load_dwordx2 v[94:95], v96, s[36:39], s56 offen sc1
    s_waitcnt vmcnt(0)
    v_cmp_ne_u32 vcc, s98, v94
    s_cbranch_vccz XCD_18
    s_cmp_eq_u32 s70, 0
    s_cbranch_scc1 XCD_18
    s_sub_u32 s70, s70, 1
    s_branch XC_17
XCD_18:
    v_cmp_ne_u32 vcc, s57, v95
    s_cmp_eq_u64 vcc, 0
    s_cselect_b32 s33, 1, 0
    s_mov_b64 exec, -1
    s_cmp_eq_u32 s33, 0
    s_cbranch_scc1 NPD_19
    v_mov_b32 v12, -1
    buffer_store_dword v12, v92, s[36:39], s96 offen
NPD_19:
IW_16:
    s_cmp_lg_u32 s30, 0
    s_cbranch_scc1 IW_20
    s_lshl_b32 s56, s31, 11
    s_add_u32 s56, s56, s94
    s_add_u32 s56, s56, 1792
    v_mov_b32 v13, 0
    s_mov_b64 exec, 1
POLL_21:
    buffer_load_dwordx2 v[66:67], v13, s[36:39], s56 offen sc1
    s_waitcnt vmcnt(0)
    v_max_u32 v12, v66, v67
    v_cmp_eq_u32 vcc, -1, v12
    s_cbranch_vccz PDONE_22
    s_cmp_eq_u32 s70, 0
    s_cbranch_scc1 PDONE_22
    s_sub_u32 s70, s70, 1
    s_branch POLL_21
PDONE_22:
    s_mov_b64 exec, -1
IW_20:
    s_barrier
POLL_23:
    buffer_load_dwordx2 v[66:67], v84, s[36:39], s94 offen sc1
    s_waitcnt vmcnt(0)
    v_max_u32 v12, v66, v67
    v_cmp_eq_u32 vcc, -1, v12
    s_cbranch_vccz PDONE_24
    s_cmp_eq_u32 s70, 0
    s_cbranch_scc1 PDONE_24
    s_sub_u32 s70, s70, 1
    s_branch POLL_23
PDONE_24:
    buffer_load_dwordx4 v[68:71], v85, s[36:39], s95 offen offset:0 sc1
    buffer_load_dwordx4 v[72:75], v85, s[36:39], s95 offen offset:128 sc1
    buffer_load_dwordx4 v[76:79], v85, s[36:39], s95 offen offset:256 sc1
    buffer_load_dwordx4 v[80:83], v85, s[36:39], s95 offen offset:384 sc1
    v_mov_b32 v93, v66
    s_nop 1
    v_max_f32_dpp v93, v93, v93 row_ror:8 row_mask:0xf bank_mask:0xf
    s_nop 1
    v_max_f32_dpp v93, v93, v93 row_ror:4 row_mask:0xf bank_mask:0xf
    s_nop 1
    v_max_f32_dpp v93, v93, v93 row_ror:2 row_mask:0xf bank_mask:0xf
    s_nop 1
    v_max_f32_dpp v93, v93, v93 row_ror:1 row_mask:0xf bank_mask:0xf
    v_mov_b32 v12, v93
    s_nop 1
    v_permlane16_swap_b32 v12, v93
    v_max_f32 v93, v93, v12
    v_mov_b32 v12, v93
    s_nop 1
    v_permlane32_swap_b32 v12, v93
    v_max_f32 v93, v93, v12
    v_sub_f32 v94, v66, v93
    v_exp_f32 v94, v94
    s_nop 0
    v_mul_f32 v95, v94, v67
    s_nop 1
    v_add_f32_dpp v95, v95, v95 row_ror:8 row_mask:0xf bank_mask:0xf
    s_nop 1
    v_add_f32_dpp v95, v95, v95 row_ror:4 row_mask:0xf bank_mask:0xf
    s_nop 1
    v_add_f32_dpp v95, v95, v95 row_ror:2 row_mask:0xf bank_mask:0xf
    s_nop 1
    v_add_f32_dpp v95, v95, v95 row_ror:1 row_mask:0xf bank_mask:0xf
    v_mov_b32 v12, v95
    s_nop 1
    v_permlane16_swap_b32 v12, v95
    v_add_f32 v95, v95, v12
    v_mov_b32 v12, v95
    s_nop 1
    v_permlane32_swap_b32 v12, v95
    v_add_f32 v95, v95, v12
    v_rcp_f32 v95, v95
    s_nop 0
    v_mul_f32 v94, v94, v95
    ds_bpermute_b32 v94, v86, v94
    s_waitcnt lgkmcnt(0)
    v_cvt_pk_bf16_f32 v12, v94, v94
    v_and_b32 v13, 0xffff0000, v12
    v_sub_f32 v13, v94, v13
    v_cvt_pk_bf16_f32 v13, v13, v13
    v_perm_b32 v96, v12, v12, v4
    v_perm_b32 v100, v13, v13, v4
    v_perm_b32 v97, v12, v12, v5
    v_perm_b32 v101, v13, v13, v5
    v_perm_b32 v98, v12, v12, v6
    v_perm_b32 v102, v13, v13, v6
    v_perm_b32 v99, v12, v12, v7
    v_perm_b32 v103, v13, v13, v7
    s_waitcnt vmcnt(0)
    v_max3_u32 v12, v68, v69, v70
    v_max3_u32 v12, v12, v71, v72
    v_max3_u32 v12, v12, v73, v74
    v_max3_u32 v12, v12, v75, v76
    v_max3_u32 v12, v12, v77, v78
    v_max3_u32 v12, v12, v79, v80
    v_max3_u32 v12, v12, v81, v82
    v_max_u32 v12, v12, v83
    v_cmp_eq_u32 vcc, -1, v12
    s_cbranch_vccz OOK_25
POLL_26:
    buffer_load_dwordx4 v[68:71], v85, s[36:39], s95 offen offset:0 sc1
    buffer_load_dwordx4 v[72:75], v85, s[36:39], s95 offen offset:128 sc1
    buffer_load_dwordx4 v[76:79], v85, s[36:39], s95 offen offset:256 sc1
    buffer_load_dwordx4 v[80:83], v85, s[36:39], s95 offen offset:384 sc1
    s_waitcnt vmcnt(0)
    v_max3_u32 v12, v68, v69, v70
    v_max3_u32 v12, v12, v71, v72
    v_max3_u32 v12, v12, v73, v74
    v_max3_u32 v12, v12, v75, v76
    v_max3_u32 v12, v12, v77, v78
    v_max3_u32 v12, v12, v79, v80
    v_max3_u32 v12, v12, v81, v82
    v_max_u32 v12, v12, v83
    v_cmp_eq_u32 vcc, -1, v12
    s_cbranch_vccz PDONE_27
    s_cmp_eq_u32 s70, 0
    s_cbranch_scc1 PDONE_27
    s_sub_u32 s70, s70, 1
    s_branch POLL_26
PDONE_27:
OOK_25:
    v_mfma_f32_16x16x32_bf16 v[104:107], v[68:71], v[96:99], 0
    v_mfma_f32_16x16x32_bf16 v[108:111], v[72:75], v[96:99], 0
    v_mfma_f32_16x16x32_bf16 v[112:115], v[76:79], v[96:99], 0
    v_mfma_f32_16x16x32_bf16 v[116:119], v[80:83], v[96:99], 0
    v_mfma_f32_16x16x32_bf16 v[104:107], v[68:71], v[100:103], v[104:107]
    v_mfma_f32_16x16x32_bf16 v[108:111], v[72:75], v[100:103], v[108:111]
    v_mfma_f32_16x16x32_bf16 v[112:115], v[76:79], v[100:103], v[112:115]
    v_mfma_f32_16x16x32_bf16 v[116:119], v[80:83], v[100:103], v[116:119]
    s_mov_b32 exec_lo, 0xff00ff
    s_mov_b32 exec_hi, 0xff00ff00
    s_nop 2
    ds_write_b128 v87, v[104:107] offset:0
    ds_write_b128 v87, v[108:111] offset:256
    ds_write_b128 v87, v[112:115] offset:512
    ds_write_b128 v87, v[116:119] offset:768
    s_mov_b64 exec, -1
    s_waitcnt lgkmcnt(0)
    s_barrier
    ds_read_b32 v120, v89 offset:0
    ds_read_b32 v121, v89 offset:1024
    ds_read_b32 v122, v89 offset:2048
    ds_read_b32 v123, v89 offset:3072
    ds_read_b32 v124, v89 offset:4096
    ds_read_b32 v125, v89 offset:5120
    ds_read_b32 v126, v89 offset:6144
    ds_read_b32 v127, v89 offset:7168
    ds_read_b32 v128, v89 offset:8192
    ds_read_b32 v129, v89 offset:9216
    ds_read_b32 v130, v89 offset:10240
    ds_read_b32 v131, v89 offset:11264
    ds_read_b32 v132, v89 offset:12288
    ds_read_b32 v133, v89 offset:13312
    ds_read_b32 v134, v89 offset:14336
    ds_read_b32 v135, v89 offset:15360
    s_waitcnt lgkmcnt(0)
    v_add_f32 v120, v120, v128
    v_add_f32 v121, v121, v129
    v_add_f32 v122, v122, v130
    v_add_f32 v123, v123, v131
    v_add_f32 v124, v124, v132
    v_add_f32 v125, v125, v133
    v_add_f32 v126, v126, v134
    v_add_f32 v127, v127, v135
    v_add_f32 v120, v120, v124
    v_add_f32 v121, v121, v125
    v_add_f32 v122, v122, v126
    v_add_f32 v123, v123, v127
    v_add_f32 v120, v120, v122
    v_add_f32 v121, v121, v123
    v_add_f32 v136, v120, v121
    v_cvt_pk_bf16_f32 v136, v136, v136
    ds_bpermute_b32 v140, v90, v136 offset:0
    ds_bpermute_b32 v141, v90, v136 offset:32
    ds_bpermute_b32 v142, v90, v136 offset:64
    ds_bpermute_b32 v143, v90, v136 offset:96
    s_waitcnt lgkmcnt(0)
    v_perm_b32 v144, v140, v140, v4
    v_perm_b32 v145, v140, v140, v5
    v_perm_b32 v146, v140, v140, v6
    v_perm_b32 v147, v140, v140, v7
    v_perm_b32 v148, v141, v141, v4
    v_perm_b32 v149, v141, v141, v5
    v_perm_b32 v150, v141, v141, v6
    v_perm_b32 v151, v141, v141, v7
    v_mfma_f32_16x16x32_bf16 v[104:107], v[16:19], v[144:147], 0
    v_mfma_f32_16x16x32_bf16 v[108:111], v[20:23], v[144:147], 0
    v_mfma_f32_16x16x32_bf16 v[112:115], v[24:27], v[144:147], 0
    v_perm_b32 v144, v142, v142, v4
    v_perm_b32 v145, v142, v142, v5
    v_perm_b32 v146, v142, v142, v6
    v_perm_b32 v147, v142, v142, v7
    v_mfma_f32_16x16x32_bf16 v[104:107], v[28:31], v[148:151], v[104:107]
    v_mfma_f32_16x16x32_bf16 v[108:111], v[32:35], v[148:151], v[108:111]
    v_mfma_f32_16x16x32_bf16 v[112:115], v[36:39], v[148:151], v[112:115]
    v_perm_b32 v148, v143, v143, v4
    v_perm_b32 v149, v143, v143, v5
    v_perm_b32 v150, v143, v143, v6
    v_perm_b32 v151, v143, v143, v7
    v_mfma_f32_16x16x32_bf16 v[104:107], v[40:43], v[144:147], v[104:107]
    v_mfma_f32_16x16x32_bf16 v[108:111], v[44:47], v[144:147], v[108:111]
    v_mfma_f32_16x16x32_bf16 v[112:115], v[48:51], v[144:147], v[112:115]
    v_mfma_f32_16x16x32_bf16 v[104:107], v[52:55], v[148:151], v[104:107]
    v_mfma_f32_16x16x32_bf16 v[108:111], v[56:59], v[148:151], v[108:111]
    v_mfma_f32_16x16x32_bf16 v[112:115], v[60:63], v[148:151], v[112:115]
    s_mov_b32 exec_lo, 0xff00ff
    s_mov_b32 exec_hi, 0xff00ff00
    s_nop 3
    ds_write_b128 v88, v[104:107] offset:0
    ds_write_b128 v88, v[108:111] offset:256
    ds_write_b128 v88, v[112:115] offset:512
    s_mov_b64 exec, -1
    s_waitcnt lgkmcnt(0)
    s_barrier
    s_cmp_ge_u32 s30, 3
    s_cbranch_scc1 IW_28
    ds_read_b32 v120, v91 offset:0
    ds_read_b32 v121, v91 offset:768
    ds_read_b32 v122, v91 offset:1536
    ds_read_b32 v123, v91 offset:2304
    ds_read_b32 v124, v91 offset:3072
    ds_read_b32 v125, v91 offset:3840
    ds_read_b32 v126, v91 offset:4608
    ds_read_b32 v127, v91 offset:5376
    ds_read_b32 v128, v91 offset:6144
    ds_read_b32 v129, v91 offset:6912
    ds_read_b32 v130, v91 offset:7680
    ds_read_b32 v131, v91 offset:8448
    ds_read_b32 v132, v91 offset:9216
    ds_read_b32 v133, v91 offset:9984
    ds_read_b32 v134, v91 offset:10752
    ds_read_b32 v135, v91 offset:11520
    s_waitcnt lgkmcnt(0)
    v_add_f32 v120, v120, v128
    v_add_f32 v121, v121, v129
    v_add_f32 v122, v122, v130
    v_add_f32 v123, v123, v131
    v_add_f32 v124, v124, v132
    v_add_f32 v125, v125, v133
    v_add_f32 v126, v126, v134
    v_add_f32 v127, v127, v135
    v_add_f32 v120, v120, v124
    v_add_f32 v121, v121, v125
    v_add_f32 v122, v122, v126
    v_add_f32 v123, v123, v127
    v_add_f32 v120, v120, v122
    v_add_f32 v121, v121, v123
    v_add_f32 v136, v120, v121
    v_min_u32 v136, 0xfffffffe, v136
    s_cmp_eq_u32 s33, 0
    s_cbranch_scc1 SL_29
    buffer_store_dword v136, v92, s[36:39], s96 offen
    s_branch SLD_30
SL_29:
    buffer_store_dword v136, v92, s[36:39], s96 offen sc1
SLD_30:
IW_28:
    s_branch L_FIN
L_ROLE_FFN:
    s_cmp_ge_u32 s32, 15
    s_cbranch_scc1 L_FIN
    s_mul_i32 s35, s31, 3
    s_add_u32 s35, s35, s32
    s_sub_u32 s35, s35, 12
    s_mov_b32 s48, s18
    s_and_b32 s49, s19, 0xffff
    s_mov_b32 s50, 1966080
    s_mov_b32 s51, 0x20000
    s_mov_b32 s52, s20
    s_and_b32 s53, s21, 0xffff
    s_mov_b32 s54, 1966080
    s_mov_b32 s55, 0x20000
    v_lshrrev_b32 v12, 3, v2
    v_lshl_add_u32 v12, v3, 1, v12
    v_mul_u32_u24 v96, 3072, v12
    v_and_b32 v12, 7, v2
    v_lshl_add_u32 v96, v12, 4, v96
    s_mul_i32 s56, s30, 245760
    s_lshl_b32 s57, s35, 7
    s_add_u32 s56, s56, s57
    buffer_load_dwordx4 v[16:19], v96, s[48:51], s56 offen nt
    buffer_load_dwordx4 v[56:59], v96, s[52:55], s56 offen nt
    s_add_u32 s56, s56, 24576
    buffer_load_dwordx4 v[20:23], v96, s[48:51], s56 offen nt
    buffer_load_dwordx4 v[60:63], v96, s[52:55], s56 offen nt
    s_add_u32 s56, s56, 24576
    s_waitcnt vmcnt(2)
    buffer_load_dwordx4 v[24:27], v96, s[48:51], s56 offen nt
    buffer_load_dwordx4 v[64:67], v96, s[52:55], s56 offen nt
    s_add_u32 s56, s56, 24576
    s_waitcnt vmcnt(2)
    buffer_load_dwordx4 v[28:31], v96, s[48:51], s56 offen nt
    buffer_load_dwordx4 v[68:71], v96, s[52:55], s56 offen nt
    s_add_u32 s56, s56, 24576
    s_waitcnt vmcnt(2)
    buffer_load_dwordx4 v[32:35], v96, s[48:51], s56 offen nt
    buffer_load_dwordx4 v[72:75], v96, s[52:55], s56 offen nt
    s_add_u32 s56, s56, 24576
    s_waitcnt vmcnt(2)
    buffer_load_dwordx4 v[36:39], v96, s[48:51], s56 offen nt
    buffer_load_dwordx4 v[76:79], v96, s[52:55], s56 offen nt
    s_add_u32 s56, s56, 24576
    s_waitcnt vmcnt(2)
    buffer_load_dwordx4 v[40:43], v96, s[48:51], s56 offen nt
    buffer_load_dwordx4 v[80:83], v96, s[52:55], s56 offen nt
    s_add_u32 s56, s56, 24576
    s_waitcnt vmcnt(2)
    buffer_load_dwordx4 v[44:47], v96, s[48:51], s56 offen nt
    buffer_load_dwordx4 v[84:87], v96, s[52:55], s56 offen nt
    s_add_u32 s56, s56, 24576
    s_waitcnt vmcnt(2)
    buffer_load_dwordx4 v[48:51], v96, s[48:51], s56 offen nt
    buffer_load_dwordx4 v[88:91], v96, s[52:55], s56 offen nt
    s_add_u32 s56, s56, 24576
    s_waitcnt vmcnt(2)
    buffer_load_dwordx4 v[52:55], v96, s[48:51], s56 offen nt
    buffer_load_dwordx4 v[92:95], v96, s[52:55], s56 offen nt
    s_mul_i32 s56, s30, 160
    v_lshlrev_b32 v12, 2, v1
    buffer_load_dword v97, v12, s[44:47], s56 offen
    s_lshl_b32 s94, s30, 8
    s_add_u32 s94, s94, 8192
    v_and_b32 v12, 3, v1
    v_mul_u32_u24 v98, 48, v12
    v_lshrrev_b32 v12, 2, v1
    v_lshl_add_u32 v98, v12, 2, v98
    v_add_u32 v98, s94, v98
    v_mul_u32_u24 v99, 48, v3
    v_add_u32 v99, s94, v99
    v_lshrrev_b32 v12, 1, v3
    s_lshl_b32 s56, s30, 1
    v_add_u32 v12, s56, v12
    v_mul_u32_u24 v100, 256, v12
    v_and_b32 v12, 7, v2
    v_lshlrev_b32 v12, 5, v12
    v_add_u32 v100, v100, v12
    v_and_b32 v12, 1, v3
    v_lshlrev_b32 v12, 4, v12
    v_add_u32 v100, v100, v12
    v_add_u32 v100, 0, v100
    v_lshlrev_b32 v101, 2, v1
    v_add_u32 v101, 0, v101
    v_lshlrev_b32 v120, 3, v1
    s_mul_i32 s95, s30, 320
    s_add_u32 s95, s95, 139264
    s_add_u32 s96, s95, 5120
    s_add_u32 s97, s95, 10240
    s_add_u32 s62, s95, 15360
    v_and_b32 v12, 7, v1
    v_lshlrev_b32 v121, 4, v12
    v_lshl_add_u32 v121, v3, 2, v121
    s_lshl_b32 s63, s35, 7
    s_add_u32 s63, s63, 159744
    v_and_b32 v122, 7, v1
    v_lshlrev_b32 v122, 3, v122
    v_add_u32 v122, 24576, v122
    s_lshl_b32 s56, s30, 3
    s_add_u32 s56, s56, 24576
    v_mov_b32 v123, s56
    v_mov_b32 v124, 0x3f803f80
    v_mov_b32 v125, 0x3f803f80
    v_mov_b32 v126, 0x3f803f80
    v_mov_b32 v127, 0x3f803f80
    v_mov_b32 v128, 0x3f803f80
    v_mov_b32 v129, 0x3f803f80
    v_mov_b32 v130, 0x3f803f80
    v_mov_b32 v131, 0x3f803f80
    v_mov_b32 v132, 0x3f803f80
    v_mov_b32 v133, 0x3f803f80
    s_waitcnt vmcnt(0)
    v_perm_b32 v136, v124, v124, v4
    v_perm_b32 v137, v124, v124, v5
    v_perm_b32 v138, v124, v124, v6
    v_perm_b32 v139, v124, v124, v7
    v_perm_b32 v140, v125, v125, v4
    v_perm_b32 v141, v125, v125, v5
    v_perm_b32 v142, v125, v125, v6
    v_perm_b32 v143, v125, v125, v7
    v_mfma_f32_16x16x32_bf16 v[144:147], v[16:19], v[136:139], 0
    v_mfma_f32_16x16x32_bf16 v[148:151], v[56:59], v[136:139], 0
    v_perm_b32 v136, v126, v126, v4
    v_perm_b32 v137, v126, v126, v5
    v_perm_b32 v138, v126, v126, v6
    v_perm_b32 v139, v126, v126, v7
    v_mfma_f32_16x16x32_bf16 v[144:147], v[20:23], v[140:143], v[144:147]
    v_mfma_f32_16x16x32_bf16 v[148:151], v[60:63], v[140:143], v[148:151]
    v_perm_b32 v140, v127, v127, v4
    v_perm_b32 v141, v127, v127, v5
    v_perm_b32 v142, v127, v127, v6
    v_perm_b32 v143, v127, v127, v7
    v_mfma_f32_16x16x32_bf16 v[144:147], v[24:27], v[136:139], v[144:147]
    v_mfma_f32_16x16x32_bf16 v[148:151], v[64:67], v[136:139], v[148:151]
    v_perm_b32 v136, v128, v128, v4
    v_perm_b32 v137, v128, v128, v5
    v_perm_b32 v138, v128, v128, v6
    v_perm_b32 v139, v128, v128, v7
    v_mfma_f32_16x16x32_bf16 v[144:147], v[28:31], v[140:143], v[144:147]
    v_mfma_f32_16x16x32_bf16 v[148:151], v[68:71], v[140:143], v[148:151]
    v_perm_b32 v140, v129, v129, v4
    v_perm_b32 v141, v129, v129, v5
    v_perm_b32 v142, v129, v129, v6
    v_perm_b32 v143, v129, v129, v7
    v_mfma_f32_16x16x32_bf16 v[144:147], v[32:35], v[136:139], v[144:147]
    v_mfma_f32_16x16x32_bf16 v[148:151], v[72:75], v[136:139], v[148:151]
    v_perm_b32 v136, v130, v130, v4
    v_perm_b32 v137, v130, v130, v5
    v_perm_b32 v138, v130, v130, v6
    v_perm_b32 v139, v130, v130, v7
    v_mfma_f32_16x16x32_bf16 v[144:147], v[36:39], v[140:143], v[144:147]
    v_mfma_f32_16x16x32_bf16 v[148:151], v[76:79], v[140:143], v[148:151]
    v_perm_b32 v140, v131, v131, v4
    v_perm_b32 v141, v131, v131, v5
    v_perm_b32 v142, v131, v131, v6
    v_perm_b32 v143, v131, v131, v7
    v_mfma_f32_16x16x32_bf16 v[144:147], v[40:43], v[136:139], v[144:147]
    v_mfma_f32_16x16x32_bf16 v[148:151], v[80:83], v[136:139], v[148:151]
    v_perm_b32 v136, v132, v132, v4
    v_perm_b32 v137, v132, v132, v5
    v_perm_b32 v138, v132, v132, v6
    v_perm_b32 v139, v132, v132, v7
    v_mfma_f32_16x16x32_bf16 v[144:147], v[44:47], v[140:143], v[144:147]
    v_mfma_f32_16x16x32_bf16 v[148:151], v[84:87], v[140:143], v[148:151]
    v_perm_b32 v140, v133, v133, v4
    v_perm_b32 v141, v133, v133, v5
    v_perm_b32 v142, v133, v133, v6
    v_perm_b32 v143, v133, v133, v7
    v_mfma_f32_16x16x32_bf16 v[144:147], v[48:51], v[136:139], v[144:147]
    v_mfma_f32_16x16x32_bf16 v[148:151], v[88:91], v[136:139], v[148:151]
    v_mfma_f32_16x16x32_bf16 v[144:147], v[52:55], v[140:143], v[144:147]
    v_mfma_f32_16x16x32_bf16 v[148:151], v[92:95], v[140:143], v[148:151]
    v_add_u32 v13, 16384, v100
    s_mov_b32 exec_lo, 0xff00ff
    s_mov_b32 exec_hi, 0xff00ff00
    s_nop 3
    ds_write_b128 v13, v[144:147]
    ds_write_b128 v13, v[148:151] offset:4096
    s_mov_b64 exec, -1
    s_waitcnt lgkmcnt(0)
    s_barrier
    v_add_u32 v13, 16384, v101
    ds_read_b32 v124, v13 offset:0
    ds_read_b32 v125, v13 offset:256
    ds_read_b32 v126, v13 offset:512
    ds_read_b32 v127, v13 offset:768
    ds_read_b32 v128, v13 offset:1024
    ds_read_b32 v129, v13 offset:1280
    ds_read_b32 v130, v13 offset:1536
    ds_read_b32 v131, v13 offset:1792
    ds_read_b32 v132, v13 offset:2048
    ds_read_b32 v133, v13 offset:2304
    ds_read_b32 v134, v13 offset:2560
    ds_read_b32 v135, v13 offset:2816
    ds_read_b32 v136, v13 offset:3072
    ds_read_b32 v137, v13 offset:3328
    ds_read_b32 v138, v13 offset:3584
    ds_read_b32 v139, v13 offset:3840
    s_waitcnt lgkmcnt(0)
    v_add_f32 v124, v124, v132
    v_add_f32 v125, v125, v133
    v_add_f32 v126, v126, v134
    v_add_f32 v127, v127, v135
    v_add_f32 v128, v128, v136
    v_add_f32 v129, v129, v137
    v_add_f32 v130, v130, v138
    v_add_f32 v131, v131, v139
    v_add_f32 v124, v124, v128
    v_add_f32 v125, v125, v129
    v_add_f32 v126, v126, v130
    v_add_f32 v127, v127, v131
    v_add_f32 v124, v124, v126
    v_add_f32 v125, v125, v127
    v_add_f32 v102, v124, v125
    v_add_u32 v13, 4096, v13
    ds_read_b32 v124, v13 offset:0
    ds_read_b32 v125, v13 offset:256
    ds_read_b32 v126, v13 offset:512
    ds_read_b32 v127, v13 offset:768
    ds_read_b32 v128, v13 offset:1024
    ds_read_b32 v129, v13 offset:1280
    ds_read_b32 v130, v13 offset:1536
    ds_read_b32 v131, v13 offset:1792
    ds_read_b32 v132, v13 offset:2048
    ds_read_b32 v133, v13 offset:2304
    ds_read_b32 v134, v13 offset:2560
    ds_read_b32 v135, v13 offset:2816
    ds_read_b32 v136, v13 offset:3072
    ds_read_b32 v137, v13 offset:3328
    ds_read_b32 v138, v13 offset:3584
    ds_read_b32 v139, v13 offset:3840
    s_waitcnt lgkmcnt(0)
    v_add_f32 v124, v124, v132
    v_add_f32 v125, v125, v133
    v_add_f32 v126, v126, v134
    v_add_f32 v127, v127, v135
    v_add_f32 v128, v128, v136
    v_add_f32 v129, v129, v137
    v_add_f32 v130, v130, v138
    v_add_f32 v131, v131, v139
    v_add_f32 v124, v124, v128
    v_add_f32 v125, v125, v129
    v_add_f32 v126, v126, v130
    v_add_f32 v127, v127, v131
    v_add_f32 v124, v124, v126
    v_add_f32 v125, v125, v127
    v_add_f32 v103, v124, v125
    s_mov_b32 exec_lo, 0xffffffff
    s_mov_b32 exec_hi, 0xff
POLL_31:
    buffer_load_dwordx2 v[104:105], v120, s[36:39], s95 offen offset:0 sc1
    buffer_load_dwordx2 v[106:107], v120, s[36:39], s95 offen offset:2560 sc1
    buffer_load_dwordx2 v[108:109], v120, s[36:39], s96 offen offset:0 sc1
    buffer_load_dwordx2 v[110:111], v120, s[36:39], s96 offen offset:2560 sc1
    buffer_load_dwordx2 v[112:113], v120, s[36:39], s97 offen offset:0 sc1
    buffer_load_dwordx2 v[114:115], v120, s[36:39], s97 offen offset:2560 sc1
    buffer_load_dwordx2 v[116:117], v120, s[36:39], s62 offen offset:0 sc1
    buffer_load_dwordx2 v[118:119], v120, s[36:39], s62 offen offset:2560 sc1
    s_waitcnt vmcnt(0)
    v_max3_u32 v12, v104, v105, v106
    v_max3_u32 v12, v12, v107, v108
    v_max3_u32 v12, v12, v109, v110
    v_max3_u32 v12, v12, v111, v112
    v_max3_u32 v12, v12, v113, v114
    v_max3_u32 v12, v12, v115, v116
    v_max3_u32 v12, v12, v117, v118
    v_max_u32 v12, v12, v119
    v_cmp_eq_u32 vcc, -1, v12
    s_cbranch_vccz PDONE_32
    s_cmp_eq_u32 s70, 0
    s_cbranch_scc1 PDONE_32
    s_sub_u32 s70, s70, 1
    s_branch POLL_31
PDONE_32:
    s_mov_b64 exec, -1
    v_add_f32 v104, v104, v112
    v_add_f32 v105, v105, v113
    v_add_f32 v106, v106, v114
    v_add_f32 v107, v107, v115
    v_add_f32 v108, v108, v116
    v_add_f32 v109, v109, v117
    v_add_f32 v110, v110, v118
    v_add_f32 v111, v111, v119
    v_add_f32 v104, v104, v108
    v_add_f32 v105, v105, v109
    v_add_f32 v106, v106, v110
    v_add_f32 v107, v107, v111
    v_add_f32 v104, v104, v106
    v_add_f32 v105, v105, v107
    v_lshlrev_b32 v12, 16, v97
    v_and_b32 v13, 0xffff0000, v97
    v_add_f32 v104, v104, v12
    v_add_f32 v105, v105, v13
    v_cvt_pk_bf16_f32 v106, v104, v105
    s_mov_b32 exec_lo, 0xffffffff
    s_mov_b32 exec_hi, 0xff
    ds_write_b32 v98, v106
    s_mov_b64 exec, -1
    ds_read_b128 v[124:127], v99 offset:0
    ds_read_b128 v[128:131], v99 offset:16
    ds_read_b64 v[132:133], v99 offset:32
    v_cmp_gt_u32 vcc, 40, v1
    s_nop 1
    v_cndmask_b32 v104, 0, v104, vcc
    v_cndmask_b32 v105, 0, v105, vcc
    v_add_f32 v160, v104, v105
    s_nop 1
    v_add_f32_dpp v160, v160, v160 row_ror:8 row_mask:0xf bank_mask:0xf
    s_nop 1
    v_add_f32_dpp v160, v160, v160 row_ror:4 row_mask:0xf bank_mask:0xf
    s_nop 1
    v_add_f32_dpp v160, v160, v160 row_ror:2 row_mask:0xf bank_mask:0xf
    s_nop 1
    v_add_f32_dpp v160, v160, v160 row_ror:1 row_mask:0xf bank_mask:0xf
    v_mov_b32 v12, v160
    s_nop 1
    v_permlane16_swap_b32 v12, v160
    v_add_f32 v160, v160, v12
    v_mov_b32 v12, v160
    s_nop 1
    v_permlane32_swap_b32 v12, v160
    v_add_f32 v160, v160, v12
    v_mul_f32 v162, 0.0125, v160
    v_sub_f32 v163, v104, v162
    v_sub_f32 v164, v105, v162
    v_cndmask_b32 v163, 0, v163, vcc
    v_cndmask_b32 v164, 0, v164, vcc
    v_mul_f32 v161, v163, v163
    v_fmac_f32 v161, v164, v164
    s_waitcnt lgkmcnt(0)
    v_perm_b32 v136, v124, v124, v4
    v_perm_b32 v137, v124, v124, v5
    v_perm_b32 v138, v124, v124, v6
    v_perm_b32 v139, v124, v124, v7
    v_perm_b32 v140, v125, v125, v4
    v_perm_b32 v141, v125, v125, v5
    v_perm_b32 v142, v125, v125, v6
    v_perm_b32 v143, v125, v125, v7
    v_mfma_f32_16x16x32_bf16 v[144:147], v[16:19], v[136:139], 0
    v_mfma_f32_16x16x32_bf16 v[148:151], v[56:59], v[136:139], 0
    v_perm_b32 v136, v126, v126, v4
    v_perm_b32 v137, v126, v126, v5
    v_perm_b32 v138, v126, v126, v6
    v_perm_b32 v139, v126, v126, v7
    v_mfma_f32_16x16x32_bf16 v[144:147], v[20:23], v[140:143], v[144:147]
    v_mfma_f32_16x16x32_bf16 v[148:151], v[60:63], v[140:143], v[148:151]
    v_perm_b32 v140, v127, v127, v4
    v_perm_b32 v141, v127, v127, v5
    v_perm_b32 v142, v127, v127, v6
    v_perm_b32 v143, v127, v127, v7
    v_mfma_f32_16x16x32_bf16 v[144:147], v[24:27], v[136:139], v[144:147]
    v_mfma_f32_16x16x32_bf16 v[148:151], v[64:67], v[136:139], v[148:151]
    v_perm_b32 v136, v128, v128, v4
    v_perm_b32 v137, v128, v128, v5
    v_perm_b32 v138, v128, v128, v6
    v_perm_b32 v139, v128, v128, v7
    v_mfma_f32_16x16x32_bf16 v[144:147], v[28:31], v[140:143], v[144:147]
    v_mfma_f32_16x16x32_bf16 v[148:151], v[68:71], v[140:143], v[148:151]
    v_perm_b32 v140, v129, v129, v4
    v_perm_b32 v141, v129, v129, v5
    v_perm_b32 v142, v129, v129, v6
    v_perm_b32 v143, v129, v129, v7
    v_mfma_f32_16x16x32_bf16 v[144:147], v[32:35], v[136:139], v[144:147]
    v_mfma_f32_16x16x32_bf16 v[148:151], v[72:75], v[136:139], v[148:151]
    v_perm_b32 v136, v130, v130, v4
    v_perm_b32 v137, v130, v130, v5
    v_perm_b32 v138, v130, v130, v6
    v_perm_b32 v139, v130, v130, v7
    v_mfma_f32_16x16x32_bf16 v[144:147], v[36:39], v[140:143], v[144:147]
    v_mfma_f32_16x16x32_bf16 v[148:151], v[76:79], v[140:143], v[148:151]
    v_perm_b32 v140, v131, v131, v4
    v_perm_b32 v141, v131, v131, v5
    v_perm_b32 v142, v131, v131, v6
    v_perm_b32 v143, v131, v131, v7
    v_mfma_f32_16x16x32_bf16 v[144:147], v[40:43], v[136:139], v[144:147]
    v_mfma_f32_16x16x32_bf16 v[148:151], v[80:83], v[136:139], v[148:151]
    v_perm_b32 v136, v132, v132, v4
    v_perm_b32 v137, v132, v132, v5
    v_perm_b32 v138, v132, v132, v6
    v_perm_b32 v139, v132, v132, v7
    v_mfma_f32_16x16x32_bf16 v[144:147], v[44:47], v[140:143], v[144:147]
    v_mfma_f32_16x16x32_bf16 v[148:151], v[84:87], v[140:143], v[148:151]
    v_perm_b32 v140, v133, v133, v4
    v_perm_b32 v141, v133, v133, v5
    v_perm_b32 v142, v133, v133, v6
    v_perm_b32 v143, v133, v133, v7
    v_mfma_f32_16x16x32_bf16 v[144:147], v[48:51], v[136:139], v[144:147]
    v_mfma_f32_16x16x32_bf16 v[148:151], v[88:91], v[136:139], v[148:151]
    v_mfma_f32_16x16x32_bf16 v[144:147], v[52:55], v[140:143], v[144:147]
    v_mfma_f32_16x16x32_bf16 v[148:151], v[92:95], v[140:143], v[148:151]
    v_add_f32_dpp v161, v161, v161 row_ror:8 row_mask:0xf bank_mask:0xf
    s_nop 1
    v_add_f32_dpp v161, v161, v161 row_ror:4 row_mask:0xf bank_mask:0xf
    s_nop 1
    v_add_f32_dpp v161, v161, v161 row_ror:2 row_mask:0xf bank_mask:0xf
    s_nop 1
    v_add_f32_dpp v161, v161, v161 row_ror:1 row_mask:0xf bank_mask:0xf
    v_mov_b32 v12, v161
    s_nop 1
    v_permlane16_swap_b32 v12, v161
    v_add_f32 v161, v161, v12
    v_mov_b32 v12, v161
    s_nop 1
    v_permlane32_swap_b32 v12, v161
    v_add_f32 v161, v161, v12
    s_mov_b64 exec, 1
    ds_write_b64 v123, v[160:161]
    s_mov_b32 exec_lo, 0xff00ff
    s_mov_b32 exec_hi, 0xff00ff00
    ds_write_b128 v100, v[144:147]
    ds_write_b128 v100, v[148:151] offset:4096
    s_mov_b64 exec, -1
    s_waitcnt lgkmcnt(0)
    s_barrier
    s_cmp_lg_u32 s30, 0
    s_cbranch_scc1 L_FIN
    ds_read_b64 v[166:167], v122
    ds_read_b32 v104, v101 offset:0
    ds_read_b32 v105, v101 offset:256
    ds_read_b32 v106, v101 offset:512
    ds_read_b32 v107, v101 offset:768
    ds_read_b32 v108, v101 offset:1024
    ds_read_b32 v109, v101 offset:1280
    ds_read_b32 v110, v101 offset:1536
    ds_read_b32 v111, v101 offset:1792
    ds_read_b32 v112, v101 offset:2048
    ds_read_b32 v113, v101 offset:2304
    ds_read_b32 v114, v101 offset:2560
    ds_read_b32 v115, v101 offset:2816
    ds_read_b32 v116, v101 offset:3072
    ds_read_b32 v117, v101 offset:3328
    s_waitcnt lgkmcnt(14)
    ds_read_b32 v118, v101 offset:3584
    ds_read_b32 v119, v101 offset:3840
    v_mov_b32 v168, v166
    v_mul_f32 v12, 0.0125, v166
    s_nop 0
    v_add_f32_dpp v168, v168, v168 row_ror:4 row_mask:0xf bank_mask:0xf
    s_nop 1
    v_add_f32_dpp v168, v168, v168 row_ror:2 row_mask:0xf bank_mask:0xf
    s_nop 1
    v_add_f32_dpp v168, v168, v168 row_ror:1 row_mask:0xf bank_mask:0xf
    ds_read_b32 v124, v101 offset:4096
    ds_read_b32 v125, v101 offset:4352
    ds_read_b32 v126, v101 offset:4608
    ds_read_b32 v127, v101 offset:4864
    ds_read_b32 v128, v101 offset:5120
    ds_read_b32 v129, v101 offset:5376
    ds_read_b32 v130, v101 offset:5632
    ds_read_b32 v131, v101 offset:5888
    ds_read_b32 v132, v101 offset:6144
    ds_read_b32 v133, v101 offset:6400
    ds_read_b32 v134, v101 offset:6656
    ds_read_b32 v135, v101 offset:6912
    ds_read_b32 v136, v101 offset:7168
    ds_read_b32 v137, v101 offset:7424
    ds_read_b32 v138, v101 offset:7680
    ds_read_b32 v139, v101 offset:7936
    v_mul_f32 v168, 0.0015625, v168
    v_sub_f32 v12, v12, v168
    v_mul_f32 v12, v12, v12
    v_mov_b32 v13, 0x42a00000
    v_fmac_f32 v167, v12, v13
    s_nop 1
    v_add_f32_dpp v167, v167, v167 row_ror:4 row_mask:0xf bank_mask:0xf
    s_nop 1
    v_add_f32_dpp v167, v167, v167 row_ror:2 row_mask:0xf bank_mask:0xf
    s_nop 1
    v_add_f32_dpp v167, v167, v167 row_ror:1 row_mask:0xf bank_mask:0xf
    v_mov_b32 v12, 1e-05
    v_fmac_f32 v12, 0.0015625, v167
    v_rsq_f32 v169, v12
    s_waitcnt lgkmcnt(0)
    v_add_f32 v104, v104, v112
    v_add_f32 v124, v124, v132
    v_add_f32 v105, v105, v113
    v_add_f32 v125, v125, v133
    v_add_f32 v106, v106, v114
    v_add_f32 v126, v126, v134
    v_add_f32 v107, v107, v115
    v_add_f32 v127, v127, v135
    v_add_f32 v108, v108, v116
    v_add_f32 v128, v128, v136
    v_add_f32 v109, v109, v117
    v_add_f32 v129, v129, v137
    v_add_f32 v110, v110, v118
    v_add_f32 v130, v130, v138
    v_add_f32 v111, v111, v119
    v_add_f32 v131, v131, v139
    v_add_f32 v104, v104, v108
    v_add_f32 v124, v124, v128
    v_add_f32 v105, v105, v109
    v_add_f32 v125, v125, v129
    v_add_f32 v106, v106, v110
    v_add_f32 v126, v126, v130
    v_add_f32 v107, v107, v111
    v_add_f32 v127, v127, v131
    v_add_f32 v104, v104, v106
    v_add_f32 v124, v124, v126
    v_add_f32 v105, v105, v107
    v_add_f32 v125, v125, v127
    v_add_f32 v170, v104, v105
    v_add_f32 v171, v124, v125
    v_fma_f32 v170, -v168, v102, v170
    v_fma_f32 v171, -v168, v103, v171
    v_mul_f32 v170, v170, v169
    v_mul_f32 v171, v171, v169
    v_mul_f32 v12, -1.4426950408889634, v170
    v_exp_f32 v12, v12
    s_nop 0
    v_add_f32 v12, 1.0, v12
    v_rcp_f32 v12, v12
    s_nop 0
    v_mul_f32 v170, v12, v171
    s_nop 1
    v_mov_b32_dpp v171, v170 row_shl:8 row_mask:0xf bank_mask:0xf
    v_cvt_pk_bf16_f32 v170, v170, v171
    v_min_u32 v170, 0xfffffffe, v170
    s_mov_b32 exec_lo, 0xff00ff
    s_mov_b32 exec_hi, 0xff00ff
    buffer_store_dword v170, v121, s[36:39], s63 offen sc1
    s_mov_b64 exec, -1
    s_branch L_FIN
L_YB:
    s_cmp_lg_u32 s30, 4
    s_cbranch_scc1 IW_33
    s_cmp_lt_u32 s32, 24
    s_cbranch_scc1 NCL_34
    v_mov_b32 v32, -1
    v_mov_b32 v33, -1
    v_mov_b32 v34, -1
    v_mov_b32 v35, -1
    v_lshlrev_b32 v36, 4, v1
    s_sub_u32 s63, s2, 192
    s_mul_i32 s62, s63, 2560
    buffer_store_dwordx4 v[32:35], v36, s[36:39], s62 offen offset:0 sc1
    buffer_store_dwordx4 v[32:35], v36, s[36:39], s62 offen offset:1024 sc1
    s_mov_b32 exec_lo, 0xffffffff
    s_mov_b32 exec_hi, 0x0
    buffer_store_dwordx4 v[32:35], v36, s[36:39], s62 offen offset:2048 sc1
    s_mov_b64 exec, -1
NCL_34:
IW_33:
    s_barrier
    v_add_u32 v12, 0, v1
    v_cmp_le_u32 vcc, 96, v12
    s_nop 1
    v_cndmask_b32 v14, 0, 1, vcc
    v_mul_u32_u24 v13, 96, v14
    v_sub_u32 v17, v12, v13
    v_mul_u32_u24 v20, 98304, v14
    v_lshl_add_u32 v20, v17, 4, v20
    v_add_u32 v12, 64, v1
    v_cmp_le_u32 vcc, 96, v12
    s_nop 1
    v_cndmask_b32 v15, 0, 1, vcc
    v_mul_u32_u24 v13, 96, v15
    v_sub_u32 v18, v12, v13
    v_mul_u32_u24 v21, 98304, v15
    v_lshl_add_u32 v21, v18, 4, v21
    v_add_u32 v12, 128, v1
    v_cmp_le_u32 vcc, 96, v12
    s_nop 1
    v_cndmask_b32 v16, 0, 1, vcc
    v_mul_u32_u24 v13, 96, v16
    v_sub_u32 v19, v12, v13
    v_mul_u32_u24 v22, 98304, v16
    v_lshl_add_u32 v22, v19, 4, v22
    v_mul_u32_u24 v23, 1536, v14
    v_lshlrev_b32 v12, 1, v14
    v_xor_b32 v26, v17, v12
    v_lshlrev_b32 v26, 4, v26
    v_mul_u32_u24 v24, 1536, v15
    v_lshlrev_b32 v12, 1, v15
    v_xor_b32 v27, v18, v12
    v_lshlrev_b32 v27, 4, v27
    v_mul_u32_u24 v25, 1536, v16
    v_lshlrev_b32 v12, 1, v16
    v_xor_b32 v28, v19, v12
    v_lshlrev_b32 v28, 4, v28
    s_mov_b32 s52, s6
    s_and_b32 s53, s7, 0xffff
    s_mov_b32 s54, 6291456
    s_mov_b32 s55, 0x20000
    s_sub_u32 s59, s30, 4
    s_lshl_b32 s56, s35, 6
    s_lshl_b32 s57, s59, 4
    s_add_u32 s56, s56, s57
    s_mul_i32 s56, s56, 1536
    s_mul_i32 s58, s59, 24576
    s_cmp_lg_u32 s30, 4
    s_cbranch_scc1 IW_35
    s_cmp_lt_u32 s32, 24
    s_cbranch_scc1 NFP_36
    s_waitcnt lgkmcnt(0)
    s_add_u32 s98, s98, 0x9e3779b9
    s_xor_b32 s99, s98, 0x5bd1e995
    v_mov_b32 v36, s98
    v_mov_b32 v37, s99
    s_sub_u32 s62, s2, 192
    s_lshl_b32 s62, s62, 4
    s_add_u32 s62, s62, 3538944
    v_mov_b32 v38, 0
    s_waitcnt vmcnt(0)
    s_mov_b64 exec, 1
    buffer_store_dwordx2 v[36:37], v38, s[36:39], s62 offen sc1
    s_mov_b64 exec, -1
    s_branch NFP2_37
NFP_36:
    s_waitcnt lgkmcnt(0)
    s_add_u32 s98, s98, 0x9e3779b9
    s_xor_b32 s99, s98, 0x5bd1e995
NFP2_37:
    s_branch IWE_38
IW_35:
    s_waitcnt lgkmcnt(0)
    s_add_u32 s98, s98, 0x9e3779b9
    s_xor_b32 s99, s98, 0x5bd1e995
IWE_38:
    v_mov_b32 v32, 157964
GT_40:
    ds_read_b32 v33, v32
    s_waitcnt lgkmcnt(0)
    v_cmp_ne_u32 vcc, 1, v33
    s_cbranch_vccz GTD_41
    s_cmp_eq_u32 s70, 0
    s_cbranch_scc1 GTD_41
    s_sub_u32 s70, s70, 1
    s_branch GT_40
GTD_41:
TG0_39:
    v_add_u32 v29, v26, v23
    s_add_u32 m0, s58, 0
    s_nop 0
    buffer_load_dwordx4 v29, s[52:55], s56 offen nt lds
    v_add_u32 v29, v27, v24
    s_add_u32 m0, s58, 1024
    s_nop 0
    buffer_load_dwordx4 v29, s[52:55], s56 offen nt lds
    v_add_u32 v29, v28, v25
    s_add_u32 m0, s58, 2048
    s_nop 0
    buffer_load_dwordx4 v29, s[52:55], s56 offen nt lds
    s_add_u32 s56, s56, 3072
    v_xor_b32 v29, 64, v26
    v_add_u32 v29, v29, v23
    s_add_u32 m0, s58, 3072
    s_nop 0
    buffer_load_dwordx4 v29, s[52:55], s56 offen nt lds
    v_xor_b32 v29, 64, v27
    v_add_u32 v29, v29, v24
    s_add_u32 m0, s58, 4096
    s_nop 0
    buffer_load_dwordx4 v29, s[52:55], s56 offen nt lds
    v_xor_b32 v29, 64, v28
    v_add_u32 v29, v29, v25
    s_add_u32 m0, s58, 5120
    s_nop 0
    buffer_load_dwordx4 v29, s[52:55], s56 offen nt lds
    s_add_u32 s56, s56, 3072
    v_xor_b32 v29, 144, v26
    v_add_u32 v29, v29, v23
    s_add_u32 m0, s58, 6144
    s_nop 0
    buffer_load_dwordx4 v29, s[52:55], s56 offen nt lds
    v_xor_b32 v29, 144, v27
    v_add_u32 v29, v29, v24
    s_add_u32 m0, s58, 7168
    s_nop 0
    buffer_load_dwordx4 v29, s[52:55], s56 offen nt lds
    v_xor_b32 v29, 144, v28
    v_add_u32 v29, v29, v25
    s_add_u32 m0, s58, 8192
    s_nop 0
    buffer_load_dwordx4 v29, s[52:55], s56 offen nt lds
    s_add_u32 s56, s56, 3072
    v_xor_b32 v29, 208, v26
    v_add_u32 v29, v29, v23
    s_add_u32 m0, s58, 9216
    s_nop 0
    buffer_load_dwordx4 v29, s[52:55], s56 offen nt lds
    v_xor_b32 v29, 208, v27
    v_add_u32 v29, v29, v24
    s_add_u32 m0, s58, 10240
    s_nop 0
    buffer_load_dwordx4 v29, s[52:55], s56 offen nt lds
    v_xor_b32 v29, 208, v28
    v_add_u32 v29, v29, v25
    s_add_u32 m0, s58, 11264
    s_nop 0
    buffer_load_dwordx4 v29, s[52:55], s56 offen nt lds
    s_add_u32 s56, s56, 3072
    v_xor_b32 v29, 128, v26
    v_add_u32 v29, v29, v23
    s_add_u32 m0, s58, 12288
    s_nop 0
    buffer_load_dwordx4 v29, s[52:55], s56 offen nt lds
    v_xor_b32 v29, 128, v27
    v_add_u32 v29, v29, v24
    s_add_u32 m0, s58, 13312
    s_nop 0
    buffer_load_dwordx4 v29, s[52:55], s56 offen nt lds
    v_xor_b32 v29, 128, v28
    v_add_u32 v29, v29, v25
    s_add_u32 m0, s58, 14336
    s_nop 0
    buffer_load_dwordx4 v29, s[52:55], s56 offen nt lds
    s_add_u32 s56, s56, 3072
    v_xor_b32 v29, 192, v26
    v_add_u32 v29, v29, v23
    s_add_u32 m0, s58, 15360
    s_nop 0
    buffer_load_dwordx4 v29, s[52:55], s56 offen nt lds
    v_xor_b32 v29, 192, v27
    v_add_u32 v29, v29, v24
    s_add_u32 m0, s58, 16384
    s_nop 0
    buffer_load_dwordx4 v29, s[52:55], s56 offen nt lds
    v_xor_b32 v29, 192, v28
    v_add_u32 v29, v29, v25
    s_add_u32 m0, s58, 17408
    s_nop 0
    buffer_load_dwordx4 v29, s[52:55], s56 offen nt lds
    s_add_u32 s56, s56, 3072
    v_xor_b32 v29, 16, v26
    v_add_u32 v29, v29, v23
    s_add_u32 m0, s58, 18432
    s_nop 0
    buffer_load_dwordx4 v29, s[52:55], s56 offen nt lds
    v_xor_b32 v29, 16, v27
    v_add_u32 v29, v29, v24
    s_add_u32 m0, s58, 19456
    s_nop 0
    buffer_load_dwordx4 v29, s[52:55], s56 offen nt lds
    v_xor_b32 v29, 16, v28
    v_add_u32 v29, v29, v25
    s_add_u32 m0, s58, 20480
    s_nop 0
    buffer_load_dwordx4 v29, s[52:55], s56 offen nt lds
    s_add_u32 s56, s56, 3072
    v_xor_b32 v29, 80, v26
    v_add_u32 v29, v29, v23
    s_add_u32 m0, s58, 21504
    s_nop 0
    buffer_load_dwordx4 v29, s[52:55], s56 offen nt lds
    v_xor_b32 v29, 80, v27
    v_add_u32 v29, v29, v24
    s_add_u32 m0, s58, 22528
    s_nop 0
    buffer_load_dwordx4 v29, s[52:55], s56 offen nt lds
    v_xor_b32 v29, 80, v28
    v_add_u32 v29, v29, v25
    s_add_u32 m0, s58, 23552
    s_nop 0
    buffer_load_dwordx4 v29, s[52:55], s56 offen nt lds
    v_lshrrev_b32 v10, 3, v2
    v_mul_u32_u24 v10, 0x0202, v10
    v_add_u32 v10, 0x0100, v10
    v_lshlrev_b32 v11, 16, v10
    v_or_b32 v10, 0x0c0c0000, v10
    v_or_b32 v11, 0x00000c0c, v11
    v_and_b32 v8, 1, v2
    v_cmp_eq_u32 vcc, 1, v8
    s_nop 1
    v_cndmask_b32 v10, v10, v11, vcc
    v_bfe_u32 v11, v2, 1, 2
    v_mov_b32 v8, 0x0c0c0c0c
    v_cmp_eq_u32 vcc, 0, v11
    s_nop 1
    v_cndmask_b32 v4, v8, v10, vcc
    v_cmp_eq_u32 vcc, 1, v11
    s_nop 1
    v_cndmask_b32 v5, v8, v10, vcc
    v_cmp_eq_u32 vcc, 2, v11
    s_nop 1
    v_cndmask_b32 v6, v8, v10, vcc
    v_cmp_eq_u32 vcc, 3, v11
    s_nop 1
    v_cndmask_b32 v7, v8, v10, vcc
    s_cmp_lg_u32 s30, 7
    s_cbranch_scc1 IW_42
    s_getreg_b32 s62, hwreg(HW_REG_XCC_ID)
    s_and_b32 s62, s62, 15
    v_mov_b32 v36, s98
    v_mov_b32 v37, s62
    s_lshl_b32 s62, s2, 3
    s_add_u32 s62, s62, 3563520
    v_mov_b32 v38, 0
    s_mov_b64 exec, 1
    buffer_store_dwordx2 v[36:37], v38, s[36:39], s62 offen sc1
    s_mov_b64 exec, -1
IW_42:
    s_branch L_YJ
L_YA:
    s_cmp_lg_u32 s30, 0
    s_cbranch_scc1 IW_43
    s_cmp_lt_u32 s32, 24
    s_cbranch_scc1 TGS_44
    v_mov_b32 v28, 0
    s_mul_i32 s56, s31, 12288
    s_add_u32 s56, s56, 3604480
    s_mov_b64 exec, 1
YTR_45:
    buffer_load_dwordx4 v[24:27], v28, s[36:39], s56 offen sc1
    s_waitcnt vmcnt(0)
    v_cmp_ne_u32 vcc, s98, v26
    s_cbranch_vccz YTRD_46
    s_cmp_eq_u32 s70, 0
    s_cbranch_scc1 YTRD_46
    s_sub_u32 s70, s70, 1
    s_branch YTR_45
YTRD_46:
    s_mov_b64 exec, -1
TGS_44:
    v_mov_b32 v28, 157964
    v_mov_b32 v29, 1
    ds_write_b32 v28, v29
    s_branch IWE_47
IW_43:
    v_mov_b32 v23, 157964
GT_49:
    ds_read_b32 v24, v23
    s_waitcnt lgkmcnt(0)
    v_cmp_ne_u32 vcc, 1, v24
    s_cbranch_vccz GTD_50
    s_cmp_eq_u32 s70, 0
    s_cbranch_scc1 GTD_50
    s_sub_u32 s70, s70, 1
    s_branch GT_49
GTD_50:
NWG_48:
IWE_47:
    v_add_u32 v12, 0, v1
    v_cmp_le_u32 vcc, 96, v12
    s_nop 1
    v_cndmask_b32 v14, 0, 1, vcc
    v_mul_u32_u24 v13, 96, v14
    v_sub_u32 v17, v12, v13
    v_mul_u32_u24 v20, 98304, v14
    v_lshl_add_u32 v20, v17, 4, v20
    v_add_u32 v12, 64, v1
    v_cmp_le_u32 vcc, 96, v12
    s_nop 1
    v_cndmask_b32 v15, 0, 1, vcc
    v_mul_u32_u24 v13, 96, v15
    v_sub_u32 v18, v12, v13
    v_mul_u32_u24 v21, 98304, v15
    v_lshl_add_u32 v21, v18, 4, v21
    v_add_u32 v12, 128, v1
    v_cmp_le_u32 vcc, 96, v12
    s_nop 1
    v_cndmask_b32 v16, 0, 1, vcc
    v_mul_u32_u24 v13, 96, v16
    v_sub_u32 v19, v12, v13
    v_mul_u32_u24 v22, 98304, v16
    v_lshl_add_u32 v22, v19, 4, v22
    s_cmp_lg_u32 s30, 0
    s_cbranch_scc1 IW_51
    v_lshlrev_b32 v28, 4, v1
    s_mov_b32 s58, 3538944
FLG_52:
    buffer_load_dwordx2 v[26:27], v28, s[36:39], s58 offen sc1
    s_waitcnt vmcnt(0)
    v_xor_b32 v26, s98, v26
    v_xor_b32 v27, s99, v27
    v_or_b32 v29, v26, v27
    v_cmp_ne_u32 vcc, 0, v29
    s_cbranch_vccz FLGD_53
    s_cmp_eq_u32 s70, 0
    s_cbranch_scc1 FLGD_53
    s_sub_u32 s70, s70, 1
    s_branch FLG_52
FLGD_53:
    s_branch IWE_54
IW_51:
    v_mov_b32 v28, -1
    v_mov_b32 v29, -1
    v_mov_b32 v30, -1
    v_mov_b32 v31, -1
    s_and_b32 s56, s34, 1
    s_lshl_b32 s56, s56, 4
    s_sub_u32 s57, s30, 1
    s_mul_i32 s57, s57, 6
    s_add_u32 s56, s56, s57
    s_mul_i32 s56, s56, 98304
    s_mul_i32 s57, s35, 1536
    s_add_u32 s56, s56, s57
    s_add_u32 s56, s56, 327680
    buffer_store_dwordx4 v[28:31], v20, s[36:39], s56 offen sc1
    buffer_store_dwordx4 v[28:31], v21, s[36:39], s56 offen sc1
    buffer_store_dwordx4 v[28:31], v22, s[36:39], s56 offen sc1
    s_add_u32 s56, s56, 196608
    buffer_store_dwordx4 v[28:31], v20, s[36:39], s56 offen sc1
    buffer_store_dwordx4 v[28:31], v21, s[36:39], s56 offen sc1
    buffer_store_dwordx4 v[28:31], v22, s[36:39], s56 offen sc1
    s_add_u32 s56, s56, 196608
    s_cmp_eq_u32 s30, 3
    s_cbranch_scc1 H3C_55
    buffer_store_dwordx4 v[28:31], v20, s[36:39], s56 offen sc1
    buffer_store_dwordx4 v[28:31], v21, s[36:39], s56 offen sc1
    buffer_store_dwordx4 v[28:31], v22, s[36:39], s56 offen sc1
H3C_55:
IWE_54:
L_YJ:
    s_and_b32 s56, s34, 1
    s_lshl_b32 s56, s56, 4
    s_lshl_b32 s57, s30, 1
    s_add_u32 s56, s56, s57
    s_mul_i32 s56, s56, 98304
    s_mul_i32 s57, s35, 1536
    s_add_u32 s56, s56, s57
    s_add_u32 s97, s56, 327680
    v_and_b32 v55, 3, v2
    v_lshlrev_b32 v55, 1, v55
    v_bfe_u32 v12, v2, 2, 1
    v_or_b32 v55, v55, v12
    v_lshrrev_b32 v12, 1, v2
    v_xor_b32 v12, v12, v2
    v_and_b32 v12, 4, v12
    v_lshl_or_b32 v55, v12, 1, v55
    s_mul_i32 s56, s30, 12
    v_add_u32 v12, 0, v3
    v_add_u32 v12, s56, v12
    v_xor_b32 v12, v12, v55
    v_lshlrev_b32 v12, 4, v12
    v_mul_u32_u24 v23, 1536, v2
    v_add_u32 v23, v23, v12
    v_add_u32 v26, 73728, v23
    v_add_u32 v12, 4, v3
    v_add_u32 v12, s56, v12
    v_xor_b32 v12, v12, v55
    v_lshlrev_b32 v12, 4, v12
    v_mul_u32_u24 v24, 1536, v2
    v_add_u32 v24, v24, v12
    v_add_u32 v27, 73728, v24
    v_add_u32 v12, 8, v3
    v_add_u32 v12, s56, v12
    v_xor_b32 v12, v12, v55
    v_lshlrev_b32 v12, 4, v12
    v_mul_u32_u24 v25, 1536, v2
    v_add_u32 v25, v25, v12
    v_add_u32 v28, 73728, v25
    v_lshrrev_b32 v12, 2, v2
    v_lshl_add_u32 v58, v3, 3, v12
    v_and_b32 v13, 15, v58
    v_and_b32 v56, 3, v13
    v_lshlrev_b32 v56, 1, v56
    v_bfe_u32 v12, v13, 2, 1
    v_or_b32 v56, v56, v12
    v_lshrrev_b32 v12, 1, v13
    v_xor_b32 v12, v12, v13
    v_and_b32 v12, 4, v12
    v_lshl_or_b32 v56, v12, 1, v56
    v_lshrrev_b32 v12, 2, v2
    v_lshl_add_u32 v59, v3, 3, v12
    v_add_u32 v59, 4, v59
    v_and_b32 v13, 15, v59
    v_and_b32 v57, 3, v13
    v_lshlrev_b32 v57, 1, v57
    v_bfe_u32 v12, v13, 2, 1
    v_or_b32 v57, v57, v12
    v_lshrrev_b32 v12, 1, v13
    v_xor_b32 v12, v12, v13
    v_and_b32 v12, 4, v12
    v_lshl_or_b32 v57, v12, 1, v57
    v_mul_u32_u24 v58, 1536, v58
    v_and_b32 v12, 1, v2
    v_lshl_add_u32 v58, v12, 3, v58
    v_mul_u32_u24 v59, 1536, v59
    v_and_b32 v12, 1, v2
    v_lshl_add_u32 v59, v12, 3, v59
    v_bfe_u32 v13, v2, 1, 1
    v_add_u32 v13, s56, v13
    v_add_u32 v12, 0, v13
    v_xor_b32 v12, v12, v56
    v_lshl_add_u32 v29, v12, 4, v58
    v_add_u32 v12, 0, v13
    v_xor_b32 v12, v12, v57
    v_lshl_add_u32 v30, v12, 4, v59
    v_add_u32 v12, 2, v13
    v_xor_b32 v12, v12, v56
    v_lshl_add_u32 v31, v12, 4, v58
    v_add_u32 v12, 2, v13
    v_xor_b32 v12, v12, v57
    v_lshl_add_u32 v32, v12, 4, v59
    v_add_u32 v12, 4, v13
    v_xor_b32 v12, v12, v56
    v_lshl_add_u32 v33, v12, 4, v58
    v_add_u32 v12, 4, v13
    v_xor_b32 v12, v12, v57
    v_lshl_add_u32 v34, v12, 4, v59
    v_add_u32 v12, 6, v13
    v_xor_b32 v12, v12, v56
    v_lshl_add_u32 v35, v12, 4, v58
    v_add_u32 v12, 6, v13
    v_xor_b32 v12, v12, v57
    v_lshl_add_u32 v36, v12, 4, v59
    v_add_u32 v12, 8, v13
    v_xor_b32 v12, v12, v56
    v_lshl_add_u32 v37, v12, 4, v58
    v_add_u32 v12, 8, v13
    v_xor_b32 v12, v12, v57
    v_lshl_add_u32 v38, v12, 4, v59
    v_add_u32 v12, 10, v13
    v_xor_b32 v12, v12, v56
    v_lshl_add_u32 v39, v12, 4, v58
    v_add_u32 v12, 10, v13
    v_xor_b32 v12, v12, v57
    v_lshl_add_u32 v40, v12, 4, v59
    s_mul_i32 s56, s30, 4352
    v_mul_u32_u24 v41, 272, v2
    v_lshl_add_u32 v41, v3, 4, v41
    v_add_u32 v41, s56, v41
    v_add_u32 v41, 98304, v41
    v_lshrrev_b32 v12, 5, v1
    s_lshl_b32 s56, s30, 1
    v_add_u32 v12, s56, v12
    v_and_b32 v13, 31, v1
    v_mul_u32_u24 v42, 272, v12
    v_lshl_add_u32 v42, v13, 3, v42
    v_add_u32 v42, 98304, v42
    v_mul_u32_u24 v43, 144, v12
    v_lshl_add_u32 v43, v13, 2, v43
    v_add_u32 v43, 133120, v43
    v_lshlrev_b32 v54, 3, v12
    v_add_u32 v54, 158016, v54
    v_mul_u32_u24 v52, 1552, v2
    v_lshl_add_u32 v52, v3, 4, v52
    s_mul_i32 s56, s30, 192
    v_add_u32 v45, s56, v52
    v_add_u32 v52, 133120, v45
    v_mul_u32_u24 v45, 1552, v2
    v_lshl_add_u32 v45, v3, 3, v45
    v_add_u32 v45, s56, v45
    v_add_u32 v45, 98304, v45
    v_mul_u32_u24 v44, 144, v2
    v_lshl_add_u32 v44, v3, 4, v44
    v_add_u32 v44, 133120, v44
    s_mul_i32 s56, s30, 3104
    v_mul_u32_u24 v46, 1552, v14
    v_lshl_add_u32 v46, v17, 4, v46
    v_add_u32 v46, s56, v46
    v_add_u32 v49, 133120, v46
    v_add_u32 v46, 98304, v46
    v_mul_u32_u24 v47, 1552, v15
    v_lshl_add_u32 v47, v18, 4, v47
    v_add_u32 v47, s56, v47
    v_add_u32 v50, 133120, v47
    v_add_u32 v47, 98304, v47
    v_mul_u32_u24 v48, 1552, v16
    v_lshl_add_u32 v48, v19, 4, v48
    v_add_u32 v48, s56, v48
    v_add_u32 v51, 133120, v48
    v_add_u32 v48, 98304, v48
    v_lshlrev_b32 v53, 4, v1
    s_and_b32 s94, s34, 1
    s_mul_i32 s94, s94, 24576
    s_mul_i32 s56, s30, 3072
    s_add_u32 s94, s94, s56
    s_waitcnt vmcnt(0) lgkmcnt(0)
    s_barrier
    s_mov_b32 s65, 7
H2P_56:
    s_bitcmp1_b32 s65, 0
    s_cbranch_scc0 H2S_59
    buffer_load_dwordx4 v[56:59], v53, s[36:39], s94 offen offset:0 sc1
H2S_59:
    s_bitcmp1_b32 s65, 1
    s_cbranch_scc0 H2S_60
    buffer_load_dwordx4 v[60:63], v53, s[36:39], s94 offen offset:1024 sc1
H2S_60:
    s_bitcmp1_b32 s65, 2
    s_cbranch_scc0 H2S_61
    buffer_load_dwordx4 v[64:67], v53, s[36:39], s94 offen offset:2048 sc1
H2S_61:
H2K_58:
    s_waitcnt vmcnt(0)
    v_max3_u32 v12, v56, v57, v58
    v_max_u32 v12, v12, v59
    v_cmp_eq_u32 vcc, -1, v12
    s_cbranch_vccnz H2C_62
    s_bitset0_b32 s65, 0
H2C_62:
    v_max3_u32 v12, v60, v61, v62
    v_max_u32 v12, v12, v63
    v_cmp_eq_u32 vcc, -1, v12
    s_cbranch_vccnz H2C_63
    s_bitset0_b32 s65, 1
H2C_63:
    v_max3_u32 v12, v64, v65, v66
    v_max_u32 v12, v12, v67
    v_cmp_eq_u32 vcc, -1, v12
    s_cbranch_vccnz H2C_64
    s_bitset0_b32 s65, 2
H2C_64:
    s_cmp_eq_u32 s65, 0
    s_cbranch_scc1 H2D_57
    s_cmp_eq_u32 s70, 0
    s_cbranch_scc1 H2D_57
    s_sub_u32 s70, s70, 1
    s_branch H2P_56
H2D_57:
    ds_write_b128 v49, v[56:59]
    ds_write_b128 v50, v[60:63]
    ds_write_b128 v51, v[64:67]
    ds_read_b128 v[72:75], v23 offset:0
    ds_read_b128 v[76:79], v23 offset:24576
    ds_read_b128 v[80:83], v23 offset:49152
    ds_read_b128 v[84:87], v26 offset:0
    ds_read_b128 v[88:91], v24 offset:0
    ds_read_b128 v[92:95], v24 offset:24576
    ds_read_b128 v[96:99], v24 offset:49152
    ds_read_b128 v[100:103], v27 offset:0
    ds_read_b128 v[104:107], v25 offset:0
    ds_read_b128 v[108:111], v25 offset:24576
    ds_read_b128 v[112:115], v25 offset:49152
    ds_read_b128 v[116:119], v28 offset:0
    s_waitcnt lgkmcnt(12)
    s_barrier
    ds_read_b128 v[56:59], v52 offset:0
    ds_read_b128 v[60:63], v52 offset:64
    ds_read_b128 v[64:67], v52 offset:128
    s_waitcnt lgkmcnt(2)
    v_mfma_f32_16x16x32_bf16 v[120:123], v[72:75], v[56:59], 0
    v_mfma_f32_16x16x32_bf16 v[124:127], v[76:79], v[56:59], 0
    v_mfma_f32_16x16x32_bf16 v[128:131], v[80:83], v[56:59], 0
    v_mfma_f32_16x16x32_bf16 v[132:135], v[84:87], v[56:59], 0
    s_waitcnt lgkmcnt(1)
    v_mfma_f32_16x16x32_bf16 v[120:123], v[88:91], v[60:63], v[120:123]
    v_mfma_f32_16x16x32_bf16 v[124:127], v[92:95], v[60:63], v[124:127]
    v_mfma_f32_16x16x32_bf16 v[128:131], v[96:99], v[60:63], v[128:131]
    v_mfma_f32_16x16x32_bf16 v[132:135], v[100:103], v[60:63], v[132:135]
    s_waitcnt lgkmcnt(0)
    v_mfma_f32_16x16x32_bf16 v[120:123], v[104:107], v[64:67], v[120:123]
    v_mfma_f32_16x16x32_bf16 v[124:127], v[108:111], v[64:67], v[124:127]
    v_mfma_f32_16x16x32_bf16 v[128:131], v[112:115], v[64:67], v[128:131]
    v_mfma_f32_16x16x32_bf16 v[132:135], v[116:119], v[64:67], v[132:135]
    s_nop 4
    ds_write_b128 v41, v[120:123] offset:0
    ds_write_b128 v41, v[124:127] offset:64
    ds_write_b128 v41, v[128:131] offset:128
    ds_write_b128 v41, v[132:135] offset:192
    s_waitcnt lgkmcnt(0)
    s_barrier
    ds_read_b64 v[72:73], v42 offset:0
    ds_read_b64 v[74:75], v42 offset:4352
    ds_read_b64 v[76:77], v42 offset:8704
    ds_read_b64 v[78:79], v42 offset:13056
    ds_read_b64 v[80:81], v42 offset:17408
    ds_read_b64 v[82:83], v42 offset:21760
    ds_read_b64 v[84:85], v42 offset:26112
    ds_read_b64 v[86:87], v42 offset:30464
    s_waitcnt lgkmcnt(0)
    v_add_f32 v72, v72, v80
    v_add_f32 v73, v73, v81
    v_add_f32 v74, v74, v82
    v_add_f32 v75, v75, v83
    v_add_f32 v76, v76, v84
    v_add_f32 v77, v77, v85
    v_add_f32 v78, v78, v86
    v_add_f32 v79, v79, v87
    v_add_f32 v72, v72, v76
    v_add_f32 v73, v73, v77
    v_add_f32 v74, v74, v78
    v_add_f32 v75, v75, v79
    v_add_f32 v72, v72, v74
    v_add_f32 v73, v73, v75
    v_max_f32 v70, v72, v73
    s_nop 1
    v_max_f32_dpp v70, v70, v70 row_ror:8 row_mask:0xf bank_mask:0xf
    s_nop 1
    v_max_f32_dpp v70, v70, v70 row_ror:4 row_mask:0xf bank_mask:0xf
    s_nop 1
    v_max_f32_dpp v70, v70, v70 row_ror:2 row_mask:0xf bank_mask:0xf
    s_nop 1
    v_max_f32_dpp v70, v70, v70 row_ror:1 row_mask:0xf bank_mask:0xf
    v_mov_b32 v12, v70
    s_nop 1
    v_permlane16_swap_b32 v12, v70
    v_max_f32 v70, v70, v12
    v_sub_f32 v72, v72, v70
    v_sub_f32 v73, v73, v70
    v_exp_f32 v72, v72
    v_exp_f32 v73, v73
    s_nop 0
    v_cvt_pk_bf16_f32 v68, v72, v73
    ds_write_b32 v43, v68
    v_lshlrev_b32 v72, 16, v68
    v_and_b32 v73, 0xffff0000, v68
    v_add_f32 v71, v72, v73
    s_nop 1
    v_add_f32_dpp v71, v71, v71 row_ror:8 row_mask:0xf bank_mask:0xf
    s_nop 1
    v_add_f32_dpp v71, v71, v71 row_ror:4 row_mask:0xf bank_mask:0xf
    s_nop 1
    v_add_f32_dpp v71, v71, v71 row_ror:2 row_mask:0xf bank_mask:0xf
    s_nop 1
    v_add_f32_dpp v71, v71, v71 row_ror:1 row_mask:0xf bank_mask:0xf
    v_mov_b32 v12, v71
    s_nop 1
    v_permlane16_swap_b32 v12, v71
    v_add_f32 v71, v71, v12
    v_min_u32 v70, 0xfffffffe, v70
    v_min_u32 v71, 0xfffffffe, v71
    s_mov_b32 exec_lo, 0x1
    s_mov_b32 exec_hi, 0x1
    ds_write_b64 v54, v[70:71]
    s_mov_b64 exec, -1
    ds_read_b64_tr_b16 v[80:81], v29 offset:0
    ds_read_b64_tr_b16 v[82:83], v30 offset:0
    ds_read_b64_tr_b16 v[84:85], v29 offset:49152
    ds_read_b64_tr_b16 v[86:87], v30 offset:49152
    ds_read_b64_tr_b16 v[88:89], v31 offset:0
    ds_read_b64_tr_b16 v[90:91], v32 offset:0
    ds_read_b64_tr_b16 v[92:93], v31 offset:49152
    ds_read_b64_tr_b16 v[94:95], v32 offset:49152
    ds_read_b64_tr_b16 v[96:97], v33 offset:0
    ds_read_b64_tr_b16 v[98:99], v34 offset:0
    ds_read_b64_tr_b16 v[100:101], v33 offset:49152
    ds_read_b64_tr_b16 v[102:103], v34 offset:49152
    s_waitcnt lgkmcnt(12)
    s_barrier
    ds_read_b128 v[72:75], v44 offset:0
    ds_read_b128 v[76:79], v44 offset:64
    s_cmp_lg_u32 s30, 7
    s_cbranch_scc1 IW_65
    v_lshlrev_b32 v12, 3, v1
    v_add_u32 v13, 158016, v12
    s_mov_b32 exec_lo, 0xffff
    s_mov_b32 exec_hi, 0x0
    ds_read_b64 v[70:71], v13
    s_lshl_b32 s56, s35, 8
    s_and_b32 s57, s34, 1
    s_lshl_b32 s57, s57, 7
    s_add_u32 s56, s56, s57
    s_add_u32 s56, s56, 49152
    s_waitcnt lgkmcnt(0)
    buffer_store_dwordx2 v[70:71], v12, s[36:39], s56 offen sc1
    s_mov_b64 exec, -1
IW_65:
    s_waitcnt lgkmcnt(0)
    ds_read_b64_tr_b16 v[104:105], v35 offset:0
    ds_read_b64_tr_b16 v[106:107], v36 offset:0
    ds_read_b64_tr_b16 v[108:109], v35 offset:49152
    ds_read_b64_tr_b16 v[110:111], v36 offset:49152
    ds_read_b64_tr_b16 v[112:113], v37 offset:0
    ds_read_b64_tr_b16 v[114:115], v38 offset:0
    ds_read_b64_tr_b16 v[116:117], v37 offset:49152
    ds_read_b64_tr_b16 v[118:119], v38 offset:49152
    ds_read_b64_tr_b16 v[120:121], v39 offset:0
    ds_read_b64_tr_b16 v[122:123], v40 offset:0
    ds_read_b64_tr_b16 v[124:125], v39 offset:49152
    ds_read_b64_tr_b16 v[126:127], v40 offset:49152
    v_mfma_f32_16x16x32_bf16 v[128:131], v[80:83], v[72:75], 0
    v_mfma_f32_16x16x32_bf16 v[128:131], v[84:87], v[76:79], v[128:131]
    v_mfma_f32_16x16x32_bf16 v[132:135], v[88:91], v[72:75], 0
    v_mfma_f32_16x16x32_bf16 v[132:135], v[92:95], v[76:79], v[132:135]
    v_mfma_f32_16x16x32_bf16 v[136:139], v[96:99], v[72:75], 0
    v_mfma_f32_16x16x32_bf16 v[136:139], v[100:103], v[76:79], v[136:139]
    s_waitcnt lgkmcnt(8)
    v_mfma_f32_16x16x32_bf16 v[140:143], v[104:107], v[72:75], 0
    v_mfma_f32_16x16x32_bf16 v[140:143], v[108:111], v[76:79], v[140:143]
    s_waitcnt lgkmcnt(4)
    v_mfma_f32_16x16x32_bf16 v[144:147], v[112:115], v[72:75], 0
    v_mfma_f32_16x16x32_bf16 v[144:147], v[116:119], v[76:79], v[144:147]
    s_waitcnt lgkmcnt(0)
    v_mfma_f32_16x16x32_bf16 v[148:151], v[120:123], v[72:75], 0
    v_mfma_f32_16x16x32_bf16 v[148:151], v[124:127], v[76:79], v[148:151]
    v_cvt_pk_bf16_f32 v80, v128, v129
    v_cvt_pk_bf16_f32 v81, v130, v131
    v_min_u32 v80, 0xfffffffe, v80
    v_min_u32 v81, 0xfffffffe, v81
    ds_write_b64 v45, v[80:81] offset:0
    v_cvt_pk_bf16_f32 v82, v132, v133
    v_cvt_pk_bf16_f32 v83, v134, v135
    v_min_u32 v82, 0xfffffffe, v82
    v_min_u32 v83, 0xfffffffe, v83
    ds_write_b64 v45, v[82:83] offset:32
    v_cvt_pk_bf16_f32 v84, v136, v137
    v_cvt_pk_bf16_f32 v85, v138, v139
    v_min_u32 v84, 0xfffffffe, v84
    v_min_u32 v85, 0xfffffffe, v85
    ds_write_b64 v45, v[84:85] offset:64
    v_cvt_pk_bf16_f32 v86, v140, v141
    v_cvt_pk_bf16_f32 v87, v142, v143
    v_min_u32 v86, 0xfffffffe, v86
    v_min_u32 v87, 0xfffffffe, v87
    ds_write_b64 v45, v[86:87] offset:96
    v_cvt_pk_bf16_f32 v88, v144, v145
    v_cvt_pk_bf16_f32 v89, v146, v147
    v_min_u32 v88, 0xfffffffe, v88
    v_min_u32 v89, 0xfffffffe, v89
    ds_write_b64 v45, v[88:89] offset:128
    v_cvt_pk_bf16_f32 v90, v148, v149
    v_cvt_pk_bf16_f32 v91, v150, v151
    v_min_u32 v90, 0xfffffffe, v90
    v_min_u32 v91, 0xfffffffe, v91
    ds_write_b64 v45, v[90:91] offset:160
    s_waitcnt lgkmcnt(0)
    s_barrier
    ds_read_b128 v[92:95], v46
    ds_read_b128 v[96:99], v47
    ds_read_b128 v[100:103], v48
    s_waitcnt lgkmcnt(2)
    buffer_store_dwordx4 v[92:95], v20, s[36:39], s97 offen sc1
    s_waitcnt lgkmcnt(1)
    buffer_store_dwordx4 v[96:99], v21, s[36:39], s97 offen sc1
    s_waitcnt lgkmcnt(0)
    buffer_store_dwordx4 v[100:103], v22, s[36:39], s97 offen sc1
    s_cmp_ge_u32 s34, 10
    s_cbranch_scc1 L_YFIN
    s_barrier
    s_mov_b32 s52, s14
    s_and_b32 s53, s15, 0xffff
    s_mov_b32 s54, 7864320
    s_mov_b32 s55, 0x20000
    v_lshrrev_b32 v12, 3, v2
    v_lshl_add_u32 v12, v3, 1, v12
    v_mul_u32_u24 v72, 1280, v12
    v_and_b32 v12, 7, v2
    v_lshl_add_u32 v72, v12, 4, v72
    s_mul_i32 s56, s31, 768
    s_mul_i32 s57, s30, 96
    s_add_u32 s56, s56, s57
    s_mul_i32 s56, s56, 1280
    s_lshl_b32 s57, s34, 7
    s_add_u32 s56, s56, s57
    buffer_load_dwordx4 v[24:27], v72, s[52:55], s56 offen nt
    s_add_u32 s56, s56, 10240
    buffer_load_dwordx4 v[28:31], v72, s[52:55], s56 offen nt
    s_add_u32 s56, s56, 10240
    buffer_load_dwordx4 v[32:35], v72, s[52:55], s56 offen nt
    s_add_u32 s56, s56, 10240
    buffer_load_dwordx4 v[36:39], v72, s[52:55], s56 offen nt
    s_add_u32 s56, s56, 10240
    buffer_load_dwordx4 v[40:43], v72, s[52:55], s56 offen nt
    s_add_u32 s56, s56, 10240
    buffer_load_dwordx4 v[44:47], v72, s[52:55], s56 offen nt
    s_add_u32 s56, s56, 10240
    s_waitcnt vmcnt(5)
    buffer_load_dwordx4 v[48:51], v72, s[52:55], s56 offen nt
    s_add_u32 s56, s56, 10240
    s_waitcnt vmcnt(5)
    buffer_load_dwordx4 v[52:55], v72, s[52:55], s56 offen nt
    s_add_u32 s56, s56, 10240
    s_waitcnt vmcnt(5)
    buffer_load_dwordx4 v[56:59], v72, s[52:55], s56 offen nt
    s_add_u32 s56, s56, 10240
    s_waitcnt vmcnt(5)
    buffer_load_dwordx4 v[60:63], v72, s[52:55], s56 offen nt
    s_add_u32 s56, s56, 10240
    s_waitcnt vmcnt(5)
    buffer_load_dwordx4 v[64:67], v72, s[52:55], s56 offen nt
    s_add_u32 s56, s56, 10240
    s_waitcnt vmcnt(5)
    buffer_load_dwordx4 v[68:71], v72, s[52:55], s56 offen nt
    s_lshl_b32 s56, s30, 8
    s_add_u32 s56, s56, 8192
    v_and_b32 v12, 3, v1
    v_mul_u32_u24 v73, 48, v12
    v_lshrrev_b32 v12, 2, v1
    v_lshl_add_u32 v73, v12, 2, v73
    v_add_u32 v73, s56, v73
    v_mul_u32_u24 v74, 48, v3
    v_add_u32 v74, s56, v74
    v_lshrrev_b32 v12, 1, v3
    s_lshl_b32 s56, s30, 1
    v_add_u32 v12, s56, v12
    v_mul_u32_u24 v75, 256, v12
    v_and_b32 v12, 7, v2
    v_lshlrev_b32 v12, 5, v12
    v_add_u32 v75, v75, v12
    v_and_b32 v12, 1, v3
    v_lshlrev_b32 v12, 4, v12
    v_add_u32 v75, v75, v12
    v_add_u32 v75, 0, v75
    v_lshlrev_b32 v76, 2, v1
    v_add_u32 v76, 0, v76
    v_and_b32 v77, 7, v1
    v_lshlrev_b32 v77, 3, v77
    v_bfe_u32 v12, v1, 3, 3
    v_add_u32 v77, v77, v12
    v_and_b32 v12, 0xffffffc0, v1
    v_add_u32 v77, v77, v12
    v_lshlrev_b32 v77, 2, v77
    v_lshlrev_b32 v84, 3, v1
    s_mul_i32 s94, s31, 9216
    s_mul_i32 s56, s30, 384
    s_add_u32 s94, s94, s56
    s_add_u32 s94, s94, 65536
    s_add_u32 s95, s94, 3072
    s_add_u32 s96, s94, 6144
    s_mul_i32 s62, s31, 2560
    s_lshl_b32 s57, s34, 8
    s_add_u32 s62, s62, s57
    s_add_u32 s62, s62, 139264
    s_waitcnt vmcnt(0)
    s_mov_b32 exec_lo, 0xffffffff
    s_mov_b32 exec_hi, 0xffff
POLL_66:
    buffer_load_dwordx2 v[78:79], v84, s[36:39], s94 offen sc1
    buffer_load_dwordx2 v[80:81], v84, s[36:39], s95 offen sc1
    buffer_load_dwordx2 v[82:83], v84, s[36:39], s96 offen sc1
    s_waitcnt vmcnt(0)
    v_max3_u32 v12, v78, v79, v80
    v_max3_u32 v12, v12, v81, v82
    v_max_u32 v12, v12, v83
    v_cmp_eq_u32 vcc, -1, v12
    s_cbranch_vccz PDONE_67
    s_cmp_eq_u32 s70, 0
    s_cbranch_scc1 PDONE_67
    s_sub_u32 s70, s70, 1
    s_branch POLL_66
PDONE_67:
    s_mov_b64 exec, -1
    v_add_f32 v78, v78, v80
    v_add_f32 v79, v79, v81
    v_add_f32 v78, v78, v82
    v_add_f32 v79, v79, v83
    v_cvt_pk_bf16_f32 v78, v78, v79
    s_mov_b32 exec_lo, 0xffffffff
    s_mov_b32 exec_hi, 0xffff
    ds_write_b32 v73, v78
    s_mov_b64 exec, -1
    ds_read_b128 v[88:91], v74 offset:0
    ds_read_b128 v[92:95], v74 offset:16
    ds_read_b128 v[96:99], v74 offset:32
    s_waitcnt lgkmcnt(0)
    v_perm_b32 v100, v88, v88, v4
    v_perm_b32 v101, v88, v88, v5
    v_perm_b32 v102, v88, v88, v6
    v_perm_b32 v103, v88, v88, v7
    v_perm_b32 v104, v89, v89, v4
    v_perm_b32 v105, v89, v89, v5
    v_perm_b32 v106, v89, v89, v6
    v_perm_b32 v107, v89, v89, v7
    v_mfma_f32_16x16x32_bf16 v[108:111], v[24:27], v[100:103], 0
    v_perm_b32 v100, v90, v90, v4
    v_perm_b32 v101, v90, v90, v5
    v_perm_b32 v102, v90, v90, v6
    v_perm_b32 v103, v90, v90, v7
    v_mfma_f32_16x16x32_bf16 v[112:115], v[28:31], v[104:107], 0
    v_perm_b32 v104, v91, v91, v4
    v_perm_b32 v105, v91, v91, v5
    v_perm_b32 v106, v91, v91, v6
    v_perm_b32 v107, v91, v91, v7
    v_mfma_f32_16x16x32_bf16 v[108:111], v[32:35], v[100:103], v[108:111]
    v_perm_b32 v100, v92, v92, v4
    v_perm_b32 v101, v92, v92, v5
    v_perm_b32 v102, v92, v92, v6
    v_perm_b32 v103, v92, v92, v7
    v_mfma_f32_16x16x32_bf16 v[112:115], v[36:39], v[104:107], v[112:115]
    v_perm_b32 v104, v93, v93, v4
    v_perm_b32 v105, v93, v93, v5
    v_perm_b32 v106, v93, v93, v6
    v_perm_b32 v107, v93, v93, v7
    v_mfma_f32_16x16x32_bf16 v[108:111], v[40:43], v[100:103], v[108:111]
    v_perm_b32 v100, v94, v94, v4
    v_perm_b32 v101, v94, v94, v5
    v_perm_b32 v102, v94, v94, v6
    v_perm_b32 v103, v94, v94, v7
    v_mfma_f32_16x16x32_bf16 v[112:115], v[44:47], v[104:107], v[112:115]
    v_perm_b32 v104, v95, v95, v4
    v_perm_b32 v105, v95, v95, v5
    v_perm_b32 v106, v95, v95, v6
    v_perm_b32 v107, v95, v95, v7
    v_mfma_f32_16x16x32_bf16 v[108:111], v[48:51], v[100:103], v[108:111]
    v_perm_b32 v100, v96, v96, v4
    v_perm_b32 v101, v96, v96, v5
    v_perm_b32 v102, v96, v96, v6
    v_perm_b32 v103, v96, v96, v7
    v_mfma_f32_16x16x32_bf16 v[112:115], v[52:55], v[104:107], v[112:115]
    v_perm_b32 v104, v97, v97, v4
    v_perm_b32 v105, v97, v97, v5
    v_perm_b32 v106, v97, v97, v6
    v_perm_b32 v107, v97, v97, v7
    v_mfma_f32_16x16x32_bf16 v[108:111], v[56:59], v[100:103], v[108:111]
    v_perm_b32 v100, v98, v98, v4
    v_perm_b32 v101, v98, v98, v5
    v_perm_b32 v102, v98, v98, v6
    v_perm_b32 v103, v98, v98, v7
    v_mfma_f32_16x16x32_bf16 v[112:115], v[60:63], v[104:107], v[112:115]
    v_perm_b32 v104, v99, v99, v4
    v_perm_b32 v105, v99, v99, v5
    v_perm_b32 v106, v99, v99, v6
    v_perm_b32 v107, v99, v99, v7
    v_mfma_f32_16x16x32_bf16 v[108:111], v[64:67], v[100:103], v[108:111]
    s_nop 0
    v_mfma_f32_16x16x32_bf16 v[112:115], v[68:71], v[104:107], v[112:115]
    s_nop 7
    v_add_f32 v108, v108, v112
    v_add_f32 v109, v109, v113
    v_add_f32 v110, v110, v114
    v_add_f32 v111, v111, v115
    s_mov_b32 exec_lo, 0xff00ff
    s_mov_b32 exec_hi, 0xff00ff00
    ds_write_b128 v75, v[108:111] offset:0
    s_mov_b64 exec, -1
    s_waitcnt lgkmcnt(0)
    s_barrier
    s_cmp_lg_u32 s30, 0
    s_cbranch_scc1 L_FIN
    ds_read_b32 v116, v76 offset:0
    ds_read_b32 v117, v76 offset:256
    ds_read_b32 v118, v76 offset:512
    ds_read_b32 v119, v76 offset:768
    ds_read_b32 v120, v76 offset:1024
    ds_read_b32 v121, v76 offset:1280
    ds_read_b32 v122, v76 offset:1536
    ds_read_b32 v123, v76 offset:1792
    ds_read_b32 v124, v76 offset:2048
    ds_read_b32 v125, v76 offset:2304
    ds_read_b32 v126, v76 offset:2560
    ds_read_b32 v127, v76 offset:2816
    ds_read_b32 v128, v76 offset:3072
    ds_read_b32 v129, v76 offset:3328
    ds_read_b32 v130, v76 offset:3584
    ds_read_b32 v131, v76 offset:3840
    s_waitcnt lgkmcnt(0)
    v_add_f32 v116, v116, v124
    v_add_f32 v117, v117, v125
    v_add_f32 v118, v118, v126
    v_add_f32 v119, v119, v127
    v_add_f32 v120, v120, v128
    v_add_f32 v121, v121, v129
    v_add_f32 v122, v122, v130
    v_add_f32 v123, v123, v131
    v_add_f32 v116, v116, v120
    v_add_f32 v117, v117, v121
    v_add_f32 v118, v118, v122
    v_add_f32 v119, v119, v123
    v_add_f32 v116, v116, v118
    v_add_f32 v117, v117, v119
    v_add_f32 v132, v116, v117
    v_min_u32 v132, 0xfffffffe, v132
    buffer_store_dword v132, v77, s[36:39], s62 offen sc1
    s_branch L_FIN
L_YFIN:
    s_sub_u32 s97, s34, 10
    s_lshl_b32 s97, s97, 3
    s_add_u32 s97, s97, s31
    s_cmp_ge_u32 s97, 10
    s_cbranch_scc1 L_FIN
    s_barrier
    s_mov_b32 s52, s22
    s_and_b32 s53, s23, 0xffff
    s_mov_b32 s54, 1966080
    s_mov_b32 s55, 0x20000
    v_lshrrev_b32 v12, 3, v2
    v_lshl_add_u32 v12, v3, 1, v12
    v_mul_u32_u24 v120, 1280, v12
    v_and_b32 v12, 7, v2
    v_lshl_add_u32 v120, v12, 4, v120
    s_mul_i32 s56, s30, 245760
    s_lshl_b32 s57, s97, 7
    s_add_u32 s56, s56, s57
    buffer_load_dwordx4 v[24:27], v120, s[52:55], s56 offen nt
    s_add_u32 s56, s56, 10240
    buffer_load_dwordx4 v[28:31], v120, s[52:55], s56 offen nt
    s_add_u32 s56, s56, 10240
    buffer_load_dwordx4 v[32:35], v120, s[52:55], s56 offen nt
    s_add_u32 s56, s56, 10240
    buffer_load_dwordx4 v[36:39], v120, s[52:55], s56 offen nt
    s_add_u32 s56, s56, 10240
    buffer_load_dwordx4 v[40:43], v120, s[52:55], s56 offen nt
    s_add_u32 s56, s56, 10240
    buffer_load_dwordx4 v[44:47], v120, s[52:55], s56 offen nt
    s_add_u32 s56, s56, 10240
    s_waitcnt vmcnt(5)
    buffer_load_dwordx4 v[48:51], v120, s[52:55], s56 offen nt
    s_add_u32 s56, s56, 10240
    s_waitcnt vmcnt(5)
    buffer_load_dwordx4 v[52:55], v120, s[52:55], s56 offen nt
    s_add_u32 s56, s56, 10240
    s_waitcnt vmcnt(5)
    buffer_load_dwordx4 v[56:59], v120, s[52:55], s56 offen nt
    s_add_u32 s56, s56, 10240
    s_waitcnt vmcnt(5)
    buffer_load_dwordx4 v[60:63], v120, s[52:55], s56 offen nt
    s_add_u32 s56, s56, 10240
    s_waitcnt vmcnt(5)
    buffer_load_dwordx4 v[64:67], v120, s[52:55], s56 offen nt
    s_add_u32 s56, s56, 10240
    s_waitcnt vmcnt(5)
    buffer_load_dwordx4 v[68:71], v120, s[52:55], s56 offen nt
    s_add_u32 s56, s56, 10240
    s_waitcnt vmcnt(5)
    buffer_load_dwordx4 v[72:75], v120, s[52:55], s56 offen nt
    s_add_u32 s56, s56, 10240
    s_waitcnt vmcnt(5)
    buffer_load_dwordx4 v[76:79], v120, s[52:55], s56 offen nt
    s_add_u32 s56, s56, 10240
    s_waitcnt vmcnt(5)
    buffer_load_dwordx4 v[80:83], v120, s[52:55], s56 offen nt
    s_add_u32 s56, s56, 10240
    s_waitcnt vmcnt(5)
    buffer_load_dwordx4 v[84:87], v120, s[52:55], s56 offen nt
    s_add_u32 s56, s56, 10240
    s_waitcnt vmcnt(5)
    buffer_load_dwordx4 v[88:91], v120, s[52:55], s56 offen nt
    s_add_u32 s56, s56, 10240
    s_waitcnt vmcnt(5)
    buffer_load_dwordx4 v[92:95], v120, s[52:55], s56 offen nt
    s_add_u32 s56, s56, 10240
    s_waitcnt vmcnt(5)
    buffer_load_dwordx4 v[96:99], v120, s[52:55], s56 offen nt
    s_add_u32 s56, s56, 10240
    s_waitcnt vmcnt(5)
    buffer_load_dwordx4 v[100:103], v120, s[52:55], s56 offen nt
    s_add_u32 s56, s56, 10240
    s_waitcnt vmcnt(5)
    buffer_load_dwordx4 v[104:107], v120, s[52:55], s56 offen nt
    s_add_u32 s56, s56, 10240
    s_waitcnt vmcnt(5)
    buffer_load_dwordx4 v[108:111], v120, s[52:55], s56 offen nt
    s_add_u32 s56, s56, 10240
    s_waitcnt vmcnt(5)
    buffer_load_dwordx4 v[112:115], v120, s[52:55], s56 offen nt
    s_add_u32 s56, s56, 10240
    s_waitcnt vmcnt(5)
    buffer_load_dwordx4 v[116:119], v120, s[52:55], s56 offen nt
    s_mul_i32 s56, s30, 384
    s_add_u32 s56, s56, 8192
    v_lshlrev_b32 v13, 1, v1
    v_and_b32 v12, 3, v13
    v_mul_u32_u24 v121, 96, v12
    v_lshrrev_b32 v12, 2, v13
    v_lshl_add_u32 v121, v12, 2, v121
    v_add_u32 v121, s56, v121
    v_lshlrev_b32 v13, 1, v1
    v_add_u32 v13, 1, v13
    v_and_b32 v12, 3, v13
    v_mul_u32_u24 v122, 96, v12
    v_lshrrev_b32 v12, 2, v13
    v_lshl_add_u32 v122, v12, 2, v122
    v_add_u32 v122, s56, v122
    v_mul_u32_u24 v123, 96, v3
    v_add_u32 v123, s56, v123
    v_lshrrev_b32 v12, 1, v3
    s_lshl_b32 s56, s30, 1
    v_add_u32 v12, s56, v12
    v_mul_u32_u24 v124, 256, v12
    v_and_b32 v12, 7, v2
    v_lshlrev_b32 v12, 5, v12
    v_add_u32 v124, v124, v12
    v_and_b32 v12, 1, v3
    v_lshlrev_b32 v12, 4, v12
    v_add_u32 v124, v124, v12
    v_add_u32 v124, 0, v124
    v_lshlrev_b32 v125, 2, v1
    v_add_u32 v125, 0, v125
    v_and_b32 v126, 7, v1
    v_lshlrev_b32 v126, 3, v126
    v_bfe_u32 v12, v1, 3, 3
    v_add_u32 v126, v126, v12
    v_and_b32 v12, 0xffffffc0, v1
    v_add_u32 v126, v126, v12
    v_lshlrev_b32 v129, 1, v126
    v_lshlrev_b32 v126, 2, v126
    v_lshlrev_b32 v127, 3, v1
    s_lshl_b32 s56, s97, 7
    buffer_load_ushort v128, v129, s[44:47], s56 offen
    s_mul_i32 s94, s30, 384
    s_add_u32 s94, s94, 159744
    s_lshl_b32 s95, s97, 8
    s_add_u32 s95, s95, 139264
    s_mov_b32 s48, s24
    s_and_b32 s49, s25, 0xffff
    s_mov_b32 s50, 1280
    s_mov_b32 s51, 0x20000
    s_waitcnt vmcnt(0)
    s_cmp_lg_u32 s30, 0
    s_cbranch_scc1 IW_68
    s_add_u32 s57, s95, 0
    s_add_u32 s58, s95, 5120
    s_add_u32 s59, s95, 10240
    s_add_u32 s60, s95, 15360
POLL_69:
    buffer_load_dword v132, v126, s[36:39], s57 offen offset:0 sc1
    buffer_load_dword v133, v126, s[36:39], s57 offen offset:2560 sc1
    buffer_load_dword v134, v126, s[36:39], s58 offen offset:0 sc1
    buffer_load_dword v135, v126, s[36:39], s58 offen offset:2560 sc1
    buffer_load_dword v136, v126, s[36:39], s59 offen offset:0 sc1
    buffer_load_dword v137, v126, s[36:39], s59 offen offset:2560 sc1
    buffer_load_dword v138, v126, s[36:39], s60 offen offset:0 sc1
    buffer_load_dword v139, v126, s[36:39], s60 offen offset:2560 sc1
    s_waitcnt vmcnt(0)
    v_max3_u32 v12, v132, v133, v134
    v_max3_u32 v12, v12, v135, v136
    v_max3_u32 v12, v12, v137, v138
    v_max_u32 v12, v12, v139
    v_cmp_eq_u32 vcc, -1, v12
    s_cbranch_vccz PDONE_70
    s_cmp_eq_u32 s70, 0
    s_cbranch_scc1 PDONE_70
    s_sub_u32 s70, s70, 1
    s_branch POLL_69
PDONE_70:
    v_add_f32 v132, v132, v136
    v_add_f32 v133, v133, v137
    v_add_f32 v134, v134, v138
    v_add_f32 v135, v135, v139
    v_add_f32 v132, v132, v133
    v_add_f32 v134, v134, v135
    v_lshlrev_b32 v128, 16, v128
    v_add_f32 v132, v132, v134
    v_add_f32 v128, v128, v132
IW_68:
    s_mov_b32 exec_lo, 0xffffffff
    s_mov_b32 exec_hi, 0xffff
POLL_71:
    buffer_load_dwordx2 v[130:131], v127, s[36:39], s94 offen sc1
    s_waitcnt vmcnt(0)
    v_max_u32 v12, v130, v131
    v_cmp_eq_u32 vcc, -1, v12
    s_cbranch_vccz PDONE_72
    s_cmp_eq_u32 s70, 0
    s_cbranch_scc1 PDONE_72
    s_sub_u32 s70, s70, 1
    s_branch POLL_71
PDONE_72:
    s_mov_b64 exec, -1
    s_mov_b32 exec_lo, 0xffffffff
    s_mov_b32 exec_hi, 0xffff
    ds_write_b32 v121, v130
    ds_write_b32 v122, v131
    s_mov_b64 exec, -1
    ds_read_b128 v[140:143], v123 offset:0
    ds_read_b128 v[144:147], v123 offset:16
    ds_read_b128 v[148:151], v123 offset:32
    ds_read_b128 v[152:155], v123 offset:48
    ds_read_b128 v[156:159], v123 offset:64
    ds_read_b128 v[160:163], v123 offset:80
    s_waitcnt lgkmcnt(0)
    v_perm_b32 v164, v140, v140, v4
    v_perm_b32 v165, v140, v140, v5
    v_perm_b32 v166, v140, v140, v6
    v_perm_b32 v167, v140, v140, v7
    v_perm_b32 v168, v141, v141, v4
    v_perm_b32 v169, v141, v141, v5
    v_perm_b32 v170, v141, v141, v6
    v_perm_b32 v171, v141, v141, v7
    v_mfma_f32_16x16x32_bf16 v[172:175], v[24:27], v[164:167], 0
    v_perm_b32 v164, v142, v142, v4
    v_perm_b32 v165, v142, v142, v5
    v_perm_b32 v166, v142, v142, v6
    v_perm_b32 v167, v142, v142, v7
    v_mfma_f32_16x16x32_bf16 v[176:179], v[28:31], v[168:171], 0
    v_perm_b32 v168, v143, v143, v4
    v_perm_b32 v169, v143, v143, v5
    v_perm_b32 v170, v143, v143, v6
    v_perm_b32 v171, v143, v143, v7
    v_mfma_f32_16x16x32_bf16 v[172:175], v[32:35], v[164:167], v[172:175]
    v_perm_b32 v164, v144, v144, v4
    v_perm_b32 v165, v144, v144, v5
    v_perm_b32 v166, v144, v144, v6
    v_perm_b32 v167, v144, v144, v7
    v_mfma_f32_16x16x32_bf16 v[176:179], v[36:39], v[168:171], v[176:179]
    v_perm_b32 v168, v145, v145, v4
    v_perm_b32 v169, v145, v145, v5
    v_perm_b32 v170, v145, v145, v6
    v_perm_b32 v171, v145, v145, v7
    v_mfma_f32_16x16x32_bf16 v[172:175], v[40:43], v[164:167], v[172:175]
    v_perm_b32 v164, v146, v146, v4
    v_perm_b32 v165, v146, v146, v5
    v_perm_b32 v166, v146, v146, v6
    v_perm_b32 v167, v146, v146, v7
    v_mfma_f32_16x16x32_bf16 v[176:179], v[44:47], v[168:171], v[176:179]
    v_perm_b32 v168, v147, v147, v4
    v_perm_b32 v169, v147, v147, v5
    v_perm_b32 v170, v147, v147, v6
    v_perm_b32 v171, v147, v147, v7
    v_mfma_f32_16x16x32_bf16 v[172:175], v[48:51], v[164:167], v[172:175]
    v_perm_b32 v164, v148, v148, v4
    v_perm_b32 v165, v148, v148, v5
    v_perm_b32 v166, v148, v148, v6
    v_perm_b32 v167, v148, v148, v7
    v_mfma_f32_16x16x32_bf16 v[176:179], v[52:55], v[168:171], v[176:179]
    v_perm_b32 v168, v149, v149, v4
    v_perm_b32 v169, v149, v149, v5
    v_perm_b32 v170, v149, v149, v6
    v_perm_b32 v171, v149, v149, v7
    v_mfma_f32_16x16x32_bf16 v[172:175], v[56:59], v[164:167], v[172:175]
    v_perm_b32 v164, v150, v150, v4
    v_perm_b32 v165, v150, v150, v5
    v_perm_b32 v166, v150, v150, v6
    v_perm_b32 v167, v150, v150, v7
    v_mfma_f32_16x16x32_bf16 v[176:179], v[60:63], v[168:171], v[176:179]
    v_perm_b32 v168, v151, v151, v4
    v_perm_b32 v169, v151, v151, v5
    v_perm_b32 v170, v151, v151, v6
    v_perm_b32 v171, v151, v151, v7
    v_mfma_f32_16x16x32_bf16 v[172:175], v[64:67], v[164:167], v[172:175]
    v_perm_b32 v164, v152, v152, v4
    v_perm_b32 v165, v152, v152, v5
    v_perm_b32 v166, v152, v152, v6
    v_perm_b32 v167, v152, v152, v7
    v_mfma_f32_16x16x32_bf16 v[176:179], v[68:71], v[168:171], v[176:179]
    v_perm_b32 v168, v153, v153, v4
    v_perm_b32 v169, v153, v153, v5
    v_perm_b32 v170, v153, v153, v6
    v_perm_b32 v171, v153, v153, v7
    v_mfma_f32_16x16x32_bf16 v[172:175], v[72:75], v[164:167], v[172:175]
    v_perm_b32 v164, v154, v154, v4
    v_perm_b32 v165, v154, v154, v5
    v_perm_b32 v166, v154, v154, v6
    v_perm_b32 v167, v154, v154, v7
    v_mfma_f32_16x16x32_bf16 v[176:179], v[76:79], v[168:171], v[176:179]
    v_perm_b32 v168, v155, v155, v4
    v_perm_b32 v169, v155, v155, v5
    v_perm_b32 v170, v155, v155, v6
    v_perm_b32 v171, v155, v155, v7
    v_mfma_f32_16x16x32_bf16 v[172:175], v[80:83], v[164:167], v[172:175]
    v_perm_b32 v164, v156, v156, v4
    v_perm_b32 v165, v156, v156, v5
    v_perm_b32 v166, v156, v156, v6
    v_perm_b32 v167, v156, v156, v7
    v_mfma_f32_16x16x32_bf16 v[176:179], v[84:87], v[168:171], v[176:179]
    v_perm_b32 v168, v157, v157, v4
    v_perm_b32 v169, v157, v157, v5
    v_perm_b32 v170, v157, v157, v6
    v_perm_b32 v171, v157, v157, v7
    v_mfma_f32_16x16x32_bf16 v[172:175], v[88:91], v[164:167], v[172:175]
    v_perm_b32 v164, v158, v158, v4
    v_perm_b32 v165, v158, v158, v5
    v_perm_b32 v166, v158, v158, v6
    v_perm_b32 v167, v158, v158, v7
    v_mfma_f32_16x16x32_bf16 v[176:179], v[92:95], v[168:171], v[176:179]
    v_perm_b32 v168, v159, v159, v4
    v_perm_b32 v169, v159, v159, v5
    v_perm_b32 v170, v159, v159, v6
    v_perm_b32 v171, v159, v159, v7
    v_mfma_f32_16x16x32_bf16 v[172:175], v[96:99], v[164:167], v[172:175]
    v_perm_b32 v164, v160, v160, v4
    v_perm_b32 v165, v160, v160, v5
    v_perm_b32 v166, v160, v160, v6
    v_perm_b32 v167, v160, v160, v7
    v_mfma_f32_16x16x32_bf16 v[176:179], v[100:103], v[168:171], v[176:179]
    v_perm_b32 v168, v161, v161, v4
    v_perm_b32 v169, v161, v161, v5
    v_perm_b32 v170, v161, v161, v6
    v_perm_b32 v171, v161, v161, v7
    v_mfma_f32_16x16x32_bf16 v[172:175], v[104:107], v[164:167], v[172:175]
    v_perm_b32 v164, v162, v162, v4
    v_perm_b32 v165, v162, v162, v5
    v_perm_b32 v166, v162, v162, v6
    v_perm_b32 v167, v162, v162, v7
    v_mfma_f32_16x16x32_bf16 v[176:179], v[108:111], v[168:171], v[176:179]
    v_perm_b32 v168, v163, v163, v4
    v_perm_b32 v169, v163, v163, v5
    v_perm_b32 v170, v163, v163, v6
    v_perm_b32 v171, v163, v163, v7
    v_mfma_f32_16x16x32_bf16 v[172:175], v[112:115], v[164:167], v[172:175]
    s_nop 0
    v_mfma_f32_16x16x32_bf16 v[176:179], v[116:119], v[168:171], v[176:179]
    s_nop 7
    v_add_f32 v172, v172, v176
    v_add_f32 v173, v173, v177
    v_add_f32 v174, v174, v178
    v_add_f32 v175, v175, v179
    s_mov_b32 exec_lo, 0xff00ff
    s_mov_b32 exec_hi, 0xff00ff00
    ds_write_b128 v124, v[172:175] offset:0
    s_mov_b64 exec, -1
    s_waitcnt lgkmcnt(0)
    s_barrier
    s_cmp_lg_u32 s30, 0
    s_cbranch_scc1 L_FIN
    ds_read_b32 v140, v125 offset:0
    ds_read_b32 v141, v125 offset:256
    ds_read_b32 v142, v125 offset:512
    ds_read_b32 v143, v125 offset:768
    ds_read_b32 v144, v125 offset:1024
    ds_read_b32 v145, v125 offset:1280
    ds_read_b32 v146, v125 offset:1536
    ds_read_b32 v147, v125 offset:1792
    ds_read_b32 v148, v125 offset:2048
    ds_read_b32 v149, v125 offset:2304
    ds_read_b32 v150, v125 offset:2560
    ds_read_b32 v151, v125 offset:2816
    ds_read_b32 v152, v125 offset:3072
    ds_read_b32 v153, v125 offset:3328
    ds_read_b32 v154, v125 offset:3584
    ds_read_b32 v155, v125 offset:3840
    s_waitcnt lgkmcnt(0)
    v_add_f32 v140, v140, v148
    v_add_f32 v141, v141, v149
    v_add_f32 v142, v142, v150
    v_add_f32 v143, v143, v151
    v_add_f32 v144, v144, v152
    v_add_f32 v145, v145, v153
    v_add_f32 v146, v146, v154
    v_add_f32 v147, v147, v155
    v_add_f32 v140, v140, v144
    v_add_f32 v141, v141, v145
    v_add_f32 v142, v142, v146
    v_add_f32 v143, v143, v147
    v_add_f32 v140, v140, v142
    v_add_f32 v141, v141, v143
    v_add_f32 v180, v140, v141
    v_add_f32 v180, v180, v128
    v_cvt_pk_bf16_f32 v180, v180, v180
    s_lshl_b32 s56, s97, 7
    buffer_store_short v180, v129, s[48:51], s56 offen
    s_cmp_lg_u32 s97, 0
    s_cbranch_scc1 L_FIN
    v_mov_b32 v133, s98
    v_mov_b32 v134, 0
    s_mov_b32 s56, 3571712
    s_mov_b64 exec, 1
    buffer_store_dword v133, v134, s[36:39], s56 offen sc1
    s_mov_b64 exec, -1
    s_branch L_FIN
L_FIN:
L_END:
    s_endpgm
L_CODE_END:

.section .rodata,"a"
.p2align 6
.amdhsa_kernel sequential_preLN__compressed_kv_cla__glu_gated_glu__decode_kernel
  .amdhsa_next_free_vgpr 248
  .amdhsa_next_free_sgpr 102
  .amdhsa_accum_offset 248
  .amdhsa_group_segment_fixed_size 0
  .amdhsa_kernarg_size 104
  .amdhsa_user_sgpr_count 2
  .amdhsa_user_sgpr_kernarg_segment_ptr 1
  .amdhsa_system_sgpr_workgroup_id_x 1
  .amdhsa_float_denorm_mode_32 3
.end_amdhsa_kernel
```
